```python
import torch

def _softmax(x, axis=-1):
    return torch.softmax(x, dim=axis)
def _gelu(x):
    return torch.nn.functional.gelu(x, approximate="tanh")
def _silu(x):
    return torch.nn.functional.silu(x)
def _sigmoid(x):
    return torch.sigmoid(x)
def _layernorm(x, axis=-1, eps=1e-5):
    m = x.mean(dim=axis, keepdim=True)
    v = x.var(dim=axis, keepdim=True, unbiased=False)
    return (x - m) / torch.sqrt(v + eps)
def _scatter_add(tgt, idx, src, axis=0):
    return tgt.clone().index_add_(axis, idx, src)
def _segment_sum(src, seg, n):
    out = torch.zeros((n,) + src.shape[1:], dtype=src.dtype)
    return out.index_add_(0, seg, src)
def _pad(x, pw):
    flat = tuple(v for pair in reversed(pw) for v in pair)
    return torch.nn.functional.pad(x, flat)

kernel_name = 'sequential_preLN__sliding_local_dilated__glu_gated_swiglu__prompt'

def setup_inputs():

    _w = (lambda a: (lambda t: t.to(torch.bfloat16) if t.is_floating_point() else t)(torch.as_tensor(a)))
    def _A_setup():
        B, S, D = 1, 2048, 448
        return {
            "x": _w((lambda *s: torch.randn(*s, dtype=torch.bfloat16) * 0.05)(B, S, D)),
            "wqkv": _w((lambda *s: torch.randn(*s, dtype=torch.bfloat16) * 0.05)(D, 3 * D)),
            "wo": _w((lambda *s: torch.randn(*s, dtype=torch.bfloat16) * 0.05)(D, D)),
        }
    _A_in = _A_setup()

    def _B_setup():
        B, S, D, F = 1, 2048, 448, 1792
        return {
            "x": _w((lambda *s: torch.randn(*s, dtype=torch.bfloat16) * 0.05)(B, S, D)),
            "w1": _w((lambda *s: torch.randn(*s, dtype=torch.bfloat16) * 0.8)(D, F) * (2.0 / D) ** 0.5),
            "w3": _w((lambda *s: torch.randn(*s, dtype=torch.bfloat16) * 0.8)(D, F) * (2.0 / D) ** 0.5),
            "w2": _w((lambda *s: torch.randn(*s, dtype=torch.bfloat16) * 0.8)(F, D) * (2.0 / F) ** 0.5),
        }
    _B_in = _B_setup()

    return {
        "A_x": _A_in["x"],
        "A_wqkv": _A_in["wqkv"],
        "A_wo": _A_in["wo"],
        "B_x": _B_in["x"],
        "B_w1": _B_in["w1"],
        "B_w3": _B_in["w3"],
        "B_w2": _B_in["w2"],
    }

def reference(A_x, A_wqkv, A_wo, B_x, B_w1, B_w3, B_w2):
    def _A_ref(x, wqkv, wo):
        B, S, D = x.shape
        H = 16; Dh = D // H
        W, dil = 8, 2
        qkv = (lambda x, *d: x.permute(*d))((x @ wqkv).reshape(B, S, 3, H, Dh), 2, 0, 3, 1, 4)
        q, k, v = qkv[0], qkv[1], qkv[2]
        scale = Dh ** -0.5
        pos = torch.arange(S)
        off = torch.arange(W) * dil
        idx = pos[:, None] - off[None, :]
        mask = idx >= 0
        idx_c = torch.where(mask, idx, 0).reshape(-1)
        kg = k[:, :, idx_c, :].reshape(B, H, S, W, Dh)
        vg = v[:, :, idx_c, :].reshape(B, H, S, W, Dh)
        logits = torch.einsum("bhsd,bhswd->bhsw", q, kg) * scale
        logits = torch.where(mask[None, None, :, :], logits, -1e9)
        attn = _softmax(logits, axis=-1)
        o = torch.einsum("bhsw,bhswd->bhsd", attn, vg)
        return (lambda x, *d: x.permute(*d))(o, 0, 2, 1, 3).reshape(B, S, D) @ wo

    def _B_ref(x, w1, w3, w2):
        gate = torch.einsum("bsd,df->bsf", x, w1)
        up = torch.einsum("bsd,df->bsf", x, w3)
        h = _silu(gate) * up
        out = torch.einsum("bsf,fd->bsd", h, w2)
        return out

    x = A_x
    h = x + _A_ref(_layernorm(x, axis=-1), A_wqkv, A_wo)
    h2 = h + _B_ref(_layernorm(h, axis=-1), B_w1, B_w3, B_w2)
    return h2
```

```asm
; @launch grid=(256,1,1) block=(512,1,1) lds=163840
.amdgcn_target "amdgcn-amd-amdhsa--gfx950"
.text
.set NLINES_ALL, 257
.set NLINES_PER, 9
.globl sequential_preLN__sliding_local_dilated__glu_gated_swiglu__prompt_kernel
.p2align 8
.type sequential_preLN__sliding_local_dilated__glu_gated_swiglu__prompt_kernel,@function
sequential_preLN__sliding_local_dilated__glu_gated_swiglu__prompt_kernel:
  s_cmp_ge_u32 s2, 256
  s_cbranch_scc1 Lend
  s_load_dwordx16 s[4:19], s[0:1], 0
  s_load_dwordx4 s[20:23], s[0:1], 64
  v_and_b32 v1, 63, v0
  v_lshrrev_b32 v2, 6, v0
  s_and_b32 s53, s2, 7
  v_readfirstlane_b32 s52, v2
  s_lshr_b32 s54, s2, 3
  v_mov_b32 v141, 0
  s_and_b32 s55, s52, 3
  s_lshr_b32 s56, s54, 3
  s_lshl_b32 s59, s53, 2
  s_add_u32 s59, s59, s56
  s_and_b32 s60, s54, 7
  s_lshl_b32 s61, s59, 6
  s_cmp_ge_u32 s52, 4
  s_cbranch_scc1 Lloader
  v_and_b32 v22, 15, v1
  v_lshrrev_b32 v23, 4, v1
  v_min_u32 v2, 55, v1
  v_lshrrev_b32 v3, 3, v2
  v_mul_u32_u24 v3, 10240, v3
  v_and_b32 v2, 7, v2
  v_lshlrev_b32 v2, 4, v2
  v_add_u32 v2, v2, v3
  v_mov_b32 v6, 0x3f803f80
  v_mov_b32 v7, 0x3f803f80
  v_mov_b32 v8, 0x3f803f80
  v_mov_b32 v9, 0x3f803f80
  ds_write_b128 v2, v[6:9] offset:0
  v_accvgpr_write_b32 a64, v6
  v_accvgpr_write_b32 a65, v6
  v_accvgpr_write_b32 a66, v6
  v_accvgpr_write_b32 a67, v6
  v_and_b32 v2, 7, v22
  v_xor_b32 v2, v2, v23
  v_lshlrev_b32 v2, 4, v2
  v_lshlrev_b32 v3, 7, v22
  v_add_u32 v2, v2, v3
  v_mov_b32 v10, v2
  v_mov_b32 v95, 0
  v_xor_b32 v15, 64, v10
  s_add_u32 s56, s52, 0
  s_and_b32 s56, s56, 3
  s_add_u32 s56, s56, 1
  s_lshl_b32 s57, s56, 11
  v_add_u32 v11, s57, v2
  s_lshl_b32 s57, s56, 4
  v_mov_b32 v96, s57
  v_xor_b32 v16, 64, v11
  s_add_u32 s56, s52, 1
  s_and_b32 s56, s56, 3
  s_add_u32 s56, s56, 1
  s_lshl_b32 s57, s56, 11
  v_add_u32 v12, s57, v2
  s_lshl_b32 s57, s56, 4
  v_mov_b32 v97, s57
  v_xor_b32 v17, 64, v12
  s_add_u32 s56, s52, 2
  s_and_b32 s56, s56, 3
  s_add_u32 s56, s56, 1
  s_lshl_b32 s57, s56, 11
  v_add_u32 v13, s57, v2
  s_lshl_b32 s57, s56, 4
  v_mov_b32 v98, s57
  v_xor_b32 v18, 64, v13
  s_add_u32 s56, s52, 3
  s_and_b32 s56, s56, 3
  s_add_u32 s56, s56, 1
  s_lshl_b32 s57, s56, 11
  v_add_u32 v14, s57, v2
  s_lshl_b32 s57, s56, 4
  v_mov_b32 v99, s57
  v_xor_b32 v19, 64, v14
  v_lshrrev_b32 v2, 2, v22
  v_lshlrev_b32 v3, 3, v23
  v_add_u32 v3, v3, v2
  v_mul_u32_u24 v20, 384, v3
  v_lshrrev_b32 v2, 1, v2
  v_and_b32 v3, 1, v23
  v_lshlrev_b32 v3, 1, v3
  v_or_b32 v2, v2, v3
  v_xor_b32 v2, s52, v2
  v_lshlrev_b32 v2, 5, v2
  v_add_u32 v20, v20, v2
  v_and_b32 v2, 3, v1
  v_lshlrev_b32 v2, 3, v2
  v_add_u32 v20, v20, v2
  v_add_u32 v20, 71680, v20
  v_add_u32 v21, 61440, v20
  v_and_b32 v2, 3, v1
  v_cmp_eq_u32 s[68:69], 1, v2
  v_cmp_eq_u32 s[70:71], 2, v2
  v_cmp_eq_u32 s[72:73], 3, v2
  v_lshrrev_b32 v2, 2, v22
  v_cmp_eq_u32 s[74:75], v2, v23
  s_lshl_b32 s58, s52, 2
  v_add_u32 v3, s58, v23
  v_lshlrev_b32 v4, 3, v3
  v_cmp_le_u32 vcc, 7, v3
  v_add_u32 v5, 8, v4
  s_nop 0
  v_cndmask_b32 v4, v4, v5, vcc
  v_cmp_eq_u32 vcc, 14, v3
  v_mov_b32 v5, 56
  s_nop 0
  v_cndmask_b32 v4, v4, v5, vcc
  v_cmp_eq_u32 vcc, 15, v3
  v_mov_b32 v5, 120
  s_nop 0
  v_cndmask_b32 v4, v4, v5, vcc
  v_cmp_gt_u32 vcc, 14, v3
  v_mov_b32 v5, 0
  v_mov_b32 v2, 1.0
  v_cndmask_b32 v105, v5, v2, vcc
  v_add_u32 v2, v95, v22
  v_mul_u32_u24 v100, 400, v2
  v_add_u32 v100, v100, v4
  v_add_u32 v2, v96, v22
  v_lshlrev_b32 v106, 3, v2
  v_add_u32 v106, 158720, v106
  v_mul_u32_u24 v101, 400, v2
  v_add_u32 v101, v101, v4
  v_add_u32 v2, v97, v22
  v_lshlrev_b32 v107, 3, v2
  v_add_u32 v107, 158720, v107
  v_mul_u32_u24 v102, 400, v2
  v_add_u32 v102, v102, v4
  v_add_u32 v2, v98, v22
  v_lshlrev_b32 v108, 3, v2
  v_add_u32 v108, 158720, v108
  v_mul_u32_u24 v103, 400, v2
  v_add_u32 v103, v103, v4
  v_add_u32 v2, v99, v22
  v_lshlrev_b32 v109, 3, v2
  v_add_u32 v109, 158720, v109
  v_mul_u32_u24 v104, 400, v2
  v_add_u32 v104, v104, v4
  s_and_b32 s62, s52, 1
  s_lshr_b32 s63, s52, 1
  s_lshl_b32 s58, s62, 6
  s_mul_i32 s65, s63, 400
  s_add_u32 s58, s58, s65
  v_mul_u32_u24 v6, 800, v22
  v_lshlrev_b32 v7, 4, v23
  v_add_u32 v6, v6, v7
  v_add_u32 v6, s58, v6
  v_add_u32 v126, 6400, v6
  v_add_u32 v127, 128, v6
  v_add_u32 v128, 12928, v6
  v_min_u32 v8, 7, v22
  v_mul_u32_u24 v8, 800, v8
  v_add_u32 v8, v8, v7
  v_add_u32 v8, s58, v8
  v_add_u32 v131, 25728, v8
  v_lshrrev_b32 v9, 2, v22
  v_lshlrev_b32 v8, 2, v23
  v_add_u32 v9, v9, v8
  v_and_b32 v8, 3, v1
  v_lshlrev_b32 v8, 3, v8
  v_add_u32 v8, s58, v8
  v_mul_u32_u24 v7, 800, v9
  v_add_u32 v7, v7, v8
  v_add_u32 v129, 256, v7
  v_add_u32 v130, 13056, v7
  v_min_u32 v9, 7, v9
  v_mul_u32_u24 v7, 800, v9
  v_add_u32 v7, v7, v8
  v_add_u32 v132, 25856, v7
  s_cmp_eq_u32 s59, 0
  s_cselect_b32 s64, 8, 0
  v_mov_b32 v8, 0xf149f2ca
  v_mov_b32 v9, 0
  v_lshlrev_b32 v7, 2, v23
  v_sub_u32 v6, v7, v22
  v_add_u32 v6, 0xffffffff, v6
  v_cmp_gt_u32 vcc, 8, v6
  v_add_u32 v6, 0, v7
  s_nop 0
  v_cndmask_b32 v118, v8, v9, vcc
  v_cmp_le_u32 vcc, s64, v6
  s_nop 1
  v_cndmask_b32 v110, v8, v118, vcc
  v_sub_u32 v6, v7, v22
  v_add_u32 v6, 0x0, v6
  v_cmp_gt_u32 vcc, 8, v6
  v_add_u32 v6, 1, v7
  s_nop 0
  v_cndmask_b32 v119, v8, v9, vcc
  v_cmp_le_u32 vcc, s64, v6
  s_nop 1
  v_cndmask_b32 v111, v8, v119, vcc
  v_sub_u32 v6, v7, v22
  v_add_u32 v6, 0x1, v6
  v_cmp_gt_u32 vcc, 8, v6
  v_add_u32 v6, 2, v7
  s_nop 0
  v_cndmask_b32 v120, v8, v9, vcc
  v_cmp_le_u32 vcc, s64, v6
  s_nop 1
  v_cndmask_b32 v112, v8, v120, vcc
  v_sub_u32 v6, v7, v22
  v_add_u32 v6, 0x2, v6
  v_cmp_gt_u32 vcc, 8, v6
  v_add_u32 v6, 3, v7
  s_nop 0
  v_cndmask_b32 v121, v8, v9, vcc
  v_cmp_le_u32 vcc, s64, v6
  s_nop 1
  v_cndmask_b32 v113, v8, v121, vcc
  v_sub_u32 v6, v7, v22
  v_add_u32 v6, 0xf, v6
  v_cmp_gt_u32 vcc, 8, v6
  v_add_u32 v6, 16, v7
  s_nop 0
  v_cndmask_b32 v122, v8, v9, vcc
  v_cmp_le_u32 vcc, s64, v6
  s_nop 1
  v_cndmask_b32 v114, v8, v122, vcc
  v_sub_u32 v6, v7, v22
  v_add_u32 v6, 0x10, v6
  v_cmp_gt_u32 vcc, 8, v6
  v_add_u32 v6, 17, v7
  s_nop 0
  v_cndmask_b32 v123, v8, v9, vcc
  v_cmp_le_u32 vcc, s64, v6
  s_nop 1
  v_cndmask_b32 v115, v8, v123, vcc
  v_sub_u32 v6, v7, v22
  v_add_u32 v6, 0x11, v6
  v_cmp_gt_u32 vcc, 8, v6
  v_add_u32 v6, 18, v7
  s_nop 0
  v_cndmask_b32 v124, v8, v9, vcc
  v_cmp_le_u32 vcc, s64, v6
  s_nop 1
  v_cndmask_b32 v116, v8, v124, vcc
  v_sub_u32 v6, v7, v22
  v_add_u32 v6, 0x12, v6
  v_cmp_gt_u32 vcc, 8, v6
  v_add_u32 v6, 19, v7
  s_nop 0
  v_cndmask_b32 v125, v8, v9, vcc
  v_cmp_le_u32 vcc, s64, v6
  s_nop 1
  v_cndmask_b32 v117, v8, v125, vcc
  s_mov_b32 s64, 0x3e8b97f6
  s_mul_i32 s58, s62, 56
  s_mul_i32 s65, s63, 144
  s_add_u32 s58, s58, s65
  s_add_u32 s58, s58, 32768
  v_mul_u32_u24 v6, 288, v22
  v_lshlrev_b32 v8, 3, v23
  v_add_u32 v6, v6, v8
  v_add_u32 v133, s58, v6
  v_add_u32 v134, 32, v133
  v_mul_u32_u24 v6, 288, v22
  s_mul_i32 s58, s63, 144
  s_add_u32 s58, s58, 32880
  v_add_u32 v6, s58, v6
  v_cmp_eq_u32 vcc, 3, v23
  s_nop 1
  v_cndmask_b32 v134, v134, v6, vcc
  v_mul_u32_u24 v135, 144, v1
  s_lshl_b32 s58, s52, 4
  s_add_u32 s58, s58, 32768
  v_add_u32 v135, s58, v135
  v_lshrrev_b32 v6, 5, v1
  v_mul_u32_u24 v6, 28672, v6
  v_and_b32 v8, 31, v1
  v_lshlrev_b32 v8, 4, v8
  v_add_u32 v136, v6, v8
  s_mul_i32 s58, s59, 57344
  s_mul_i32 s65, s60, 3584
  s_add_u32 s58, s58, s65
  s_lshl_b32 s65, s52, 9
  s_add_u32 s58, s58, s65
  s_add_u32 s65, s58, 0x0
  s_waitcnt lgkmcnt(0)
  s_mov_b32 s32, s6
  s_mov_b32 s33, s7
  s_mov_b32 s34, 0x126000
  s_mov_b32 s35, 0x20000
  s_mov_b32 s28, s4
  s_mov_b32 s29, s5
  s_mov_b32 s30, 0x1c0000
  s_mov_b32 s31, 0x20000
  s_mov_b32 s24, s22
  s_mov_b32 s25, s23
  s_mov_b32 s26, 0x10000000
  s_mov_b32 s27, 0x20000
  s_mov_b32 s36, s8
  s_mov_b32 s37, s9
  s_mov_b32 s38, 0x62000
  s_mov_b32 s39, 0x20000
  s_cmp_lt_u32 s55, 2
  s_cselect_b32 s40, s12, s14
  s_cselect_b32 s41, s13, s15
  s_mov_b32 s42, 0x188000
  s_mov_b32 s43, 0x20000
  s_mov_b32 s44, s16
  s_mov_b32 s45, s17
  s_mov_b32 s46, 0x188000
  s_mov_b32 s47, 0x20000
  s_mov_b32 s48, s18
  s_mov_b32 s49, s19
  s_mov_b32 s50, 0x1c0000
  s_mov_b32 s51, 0x20000
  s_mov_b32 s8, s12
  s_mov_b32 s9, s13
  s_mov_b32 s10, s14
  s_mov_b32 s11, s15
  s_mov_b32 s4, s20
  s_mov_b32 s5, s21
  s_mov_b32 s6, 0x100
  s_mov_b32 s7, 0x20000
  s_cmp_lg_u32 s52, 0
  s_cbranch_scc1 Lpw_1
  v_add_u32 v2, 0, v1
  v_min_u32 v2, 62, v2
  s_mul_i32 s56, s54, 63
  v_add_u32 v2, s56, v2
  v_lshlrev_b32 v2, 7, v2
  s_mov_b32 s56, 86016
  buffer_load_dword v137, v2, s[32:35], s56 offen
Lpw_1:
  s_cmp_lg_u32 s52, 2
  s_cbranch_scc1 Lpw_3
  v_add_u32 v2, 0, v1
  v_min_u32 v2, 62, v2
  s_mul_i32 s56, s54, 63
  v_add_u32 v2, s56, v2
  v_lshlrev_b32 v2, 7, v2
  s_mov_b32 s56, 344064
  buffer_load_dword v137, v2, s[32:35], s56 offen
Lpw_3:
  s_cmp_lg_u32 s52, 1
  s_cbranch_scc1 Lpw_2
  v_min_u32 v2, 42, v1
  s_mul_i32 s56, s54, 43
  v_add_u32 v2, s56, v2
  v_min_u32 v2, 1359, v2
  v_mul_u32_u24 v3, 13108, v2
  v_lshrrev_b32 v3, 16, v3
  v_mul_u32_u24 v4, 5, v3
  v_sub_u32 v4, v2, v4
  v_mul_u32_u24 v3, 896, v3
  v_lshlrev_b32 v4, 7, v4
  v_add_u32 v3, v3, v4
  s_lshl_b32 s56, s53, 8
  s_max_u32 s56, s56, 16
  s_sub_u32 s56, s56, 16
  s_mul_i32 s56, s56, 896
  s_add_u32 s56, s56, 256
  buffer_load_dword v137, v3, s[28:31], s56 offen
Lpw_2:
  s_cmp_lg_u32 s52, 3
  s_cbranch_scc1 Lwo_4
  v_min_u32 v2, 12, v1
  s_mul_i32 s56, s2, 13
  v_add_u32 v2, s56, v2
  v_min_u32 v2, 3135, v2
  v_lshlrev_b32 v2, 7, v2
  buffer_load_dword v137, v2, s[36:39], 0 offen
Lwo_4:
  s_cmp_lg_u32 s52, 2
  s_cbranch_scc1 Lft_5
  v_lshlrev_b32 v2, 7, v1
  s_mov_b32 s56, 0xd80000
  s_mov_b32 s56, 0xd80000
  buffer_load_dword v137, v2, s[24:27], s56 offen
  s_mov_b32 s56, 0xd82000
  buffer_load_dword v137, v2, s[24:27], s56 offen
  s_mov_b32 s56, 0xd88000
  buffer_load_dword v137, v2, s[24:27], s56 offen
  s_mov_b32 s56, 0xd8a000
  buffer_load_dword v137, v2, s[24:27], s56 offen
Lft_5:
  s_or_b32 s56, s2, s52
  s_cmp_lg_u32 s56, 0
  s_cbranch_scc1 Ltag_6
  s_memrealtime s[12:13]
  s_waitcnt lgkmcnt(0)
  s_or_b32 s12, s12, 1
  v_mov_b32 v140, s12
  buffer_store_dword v140, v141, s[4:7], 0 offen sc0 sc1
Ltag_6:
  s_cmp_lg_u32 s52, 3
  s_cbranch_scc1 Lpf_7
  s_getpc_b64 s[12:13]
Lpc_ref:
  s_mul_i32 s56, s54, NLINES_PER
  v_min_u32 v2, NLINES_PER-1, v1
  v_add_u32 v2, s56, v2
  v_min_u32 v2, NLINES_ALL-1, v2
  v_lshlrev_b32 v2, 7, v2
  global_load_dword v137, v2, s[12:13]
Lpf_7:
  s_waitcnt lgkmcnt(0)
  s_barrier
  ds_read_b64_tr_b16 a[0:1], v20 offset:0
  ds_read_b64_tr_b16 a[2:3], v20 offset:1536
  ds_read_b64_tr_b16 a[4:5], v20 offset:128
  ds_read_b64_tr_b16 a[6:7], v20 offset:1664
  ds_read_b64_tr_b16 a[8:9], v20 offset:256
  ds_read_b64_tr_b16 a[10:11], v20 offset:1792
  ds_read_b128 a[24:27], v10 offset:0
  ds_read_b128 a[28:31], v11 offset:0
  ds_read_b128 a[32:35], v12 offset:0
  ds_read_b128 a[36:39], v13 offset:0
  ds_read_b128 a[40:43], v14 offset:0
  s_barrier
  s_cmp_lg_u32 s52, 0
  s_cbranch_scc1 Lpw_8
  v_add_u32 v2, 0, v1
  v_min_u32 v2, 62, v2
  s_mul_i32 s56, s54, 63
  v_add_u32 v2, s56, v2
  v_lshlrev_b32 v2, 7, v2
  s_mov_b32 s56, 602112
  buffer_load_dword v137, v2, s[32:35], s56 offen
Lpw_8:
  s_cmp_lg_u32 s52, 1
  s_cbranch_scc1 Lpw_9
  v_add_u32 v2, 0, v1
  v_min_u32 v2, 41, v2
  s_mul_i32 s56, s54, 42
  v_add_u32 v2, s56, v2
  v_lshlrev_b32 v2, 7, v2
  s_mov_b32 s56, 860160
  buffer_load_dword v137, v2, s[32:35], s56 offen
Lpw_9:
  s_cmp_lg_u32 s52, 2
  s_cbranch_scc1 Lpw_10
  v_add_u32 v2, 0, v1
  v_min_u32 v2, 41, v2
  s_mul_i32 s56, s54, 42
  v_add_u32 v2, s56, v2
  v_lshlrev_b32 v2, 7, v2
  s_mov_b32 s56, 1032192
  buffer_load_dword v137, v2, s[32:35], s56 offen
Lpw_10:
  s_waitcnt lgkmcnt(0)
  v_mfma_f32_16x16x32_bf16 v[36:39], a[0:3], a[28:31], 0
  ds_read_b64_tr_b16 a[12:13], v20 offset:12288
  v_mfma_f32_16x16x32_bf16 v[40:43], a[4:7], a[28:31], 0
  ds_read_b64_tr_b16 a[14:15], v20 offset:13824
  v_mfma_f32_16x16x32_bf16 v[44:47], a[8:11], a[28:31], 0
  ds_read_b64_tr_b16 a[16:17], v20 offset:12416
  v_mfma_f32_16x16x32_bf16 v[48:51], a[0:3], a[32:35], 0
  ds_read_b64_tr_b16 a[18:19], v20 offset:13952
  v_mfma_f32_16x16x32_bf16 v[52:55], a[4:7], a[32:35], 0
  ds_read_b64_tr_b16 a[20:21], v20 offset:12544
  v_mfma_f32_16x16x32_bf16 v[56:59], a[8:11], a[32:35], 0
  ds_read_b64_tr_b16 a[22:23], v20 offset:14080
  v_mfma_f32_16x16x32_bf16 v[60:63], a[0:3], a[36:39], 0
  ds_read_b128 a[44:47], v15 offset:0
  v_mfma_f32_16x16x32_bf16 v[64:67], a[4:7], a[36:39], 0
  ds_read_b128 a[48:51], v16 offset:0
  v_mfma_f32_16x16x32_bf16 v[68:71], a[8:11], a[36:39], 0
  ds_read_b128 a[52:55], v17 offset:0
  v_mfma_f32_16x16x32_bf16 v[72:75], a[0:3], a[40:43], 0
  ds_read_b128 a[56:59], v18 offset:0
  v_mfma_f32_16x16x32_bf16 v[76:79], a[4:7], a[40:43], 0
  ds_read_b128 a[60:63], v19 offset:0
  v_mfma_f32_16x16x32_bf16 v[80:83], a[8:11], a[40:43], 0
  v_mfma_f32_16x16x32_bf16 v[24:27], a[0:3], a[24:27], 0
  v_mfma_f32_16x16x32_bf16 v[28:31], a[4:7], a[24:27], 0
  v_mfma_f32_16x16x32_bf16 v[32:35], a[8:11], a[24:27], 0
  v_mfma_f32_16x16x32_bf16 v[84:87], a[24:27], a[24:27], 0
  v_mfma_f32_16x16x32_bf16 v[92:95], a[64:67], a[24:27], 0
  v_mfma_f32_16x16x32_bf16 v[88:91], a[28:31], a[28:31], 0
  v_mfma_f32_16x16x32_bf16 v[96:99], a[64:67], a[28:31], 0
  s_barrier
  s_waitcnt lgkmcnt(0)
  v_mfma_f32_16x16x32_bf16 v[36:39], a[12:15], a[48:51], v[36:39]
  ds_read_b64_tr_b16 a[0:1], v20 offset:24576
  v_mfma_f32_16x16x32_bf16 v[40:43], a[16:19], a[48:51], v[40:43]
  ds_read_b64_tr_b16 a[2:3], v20 offset:26112
  v_mfma_f32_16x16x32_bf16 v[44:47], a[20:23], a[48:51], v[44:47]
  ds_read_b64_tr_b16 a[4:5], v20 offset:24704
  v_mfma_f32_16x16x32_bf16 v[48:51], a[12:15], a[52:55], v[48:51]
  ds_read_b64_tr_b16 a[6:7], v20 offset:26240
  v_mfma_f32_16x16x32_bf16 v[52:55], a[16:19], a[52:55], v[52:55]
  ds_read_b64_tr_b16 a[8:9], v20 offset:24832
  v_mfma_f32_16x16x32_bf16 v[56:59], a[20:23], a[52:55], v[56:59]
  ds_read_b64_tr_b16 a[10:11], v20 offset:26368
  v_mfma_f32_16x16x32_bf16 v[60:63], a[12:15], a[56:59], v[60:63]
  ds_read_b128 a[24:27], v10 offset:10240
  v_mfma_f32_16x16x32_bf16 v[64:67], a[16:19], a[56:59], v[64:67]
  ds_read_b128 a[28:31], v11 offset:10240
  v_mfma_f32_16x16x32_bf16 v[68:71], a[20:23], a[56:59], v[68:71]
  ds_read_b128 a[32:35], v12 offset:10240
  v_mfma_f32_16x16x32_bf16 v[72:75], a[12:15], a[60:63], v[72:75]
  ds_read_b128 a[36:39], v13 offset:10240
  v_mfma_f32_16x16x32_bf16 v[76:79], a[16:19], a[60:63], v[76:79]
  ds_read_b128 a[40:43], v14 offset:10240
  v_mfma_f32_16x16x32_bf16 v[80:83], a[20:23], a[60:63], v[80:83]
  v_mfma_f32_16x16x32_bf16 v[24:27], a[12:15], a[44:47], v[24:27]
  v_mfma_f32_16x16x32_bf16 v[28:31], a[16:19], a[44:47], v[28:31]
  v_mfma_f32_16x16x32_bf16 v[32:35], a[20:23], a[44:47], v[32:35]
  v_mfma_f32_16x16x32_bf16 v[84:87], a[44:47], a[44:47], v[84:87]
  v_mfma_f32_16x16x32_bf16 v[92:95], a[64:67], a[44:47], v[92:95]
  v_mfma_f32_16x16x32_bf16 v[88:91], a[48:51], a[48:51], v[88:91]
  v_mfma_f32_16x16x32_bf16 v[96:99], a[64:67], a[48:51], v[96:99]
  s_barrier
  s_waitcnt lgkmcnt(0)
  v_mfma_f32_16x16x32_bf16 v[36:39], a[0:3], a[28:31], v[36:39]
  ds_read_b64_tr_b16 a[12:13], v20 offset:36864
  v_mfma_f32_16x16x32_bf16 v[40:43], a[4:7], a[28:31], v[40:43]
  ds_read_b64_tr_b16 a[14:15], v20 offset:38400
  v_mfma_f32_16x16x32_bf16 v[44:47], a[8:11], a[28:31], v[44:47]
  ds_read_b64_tr_b16 a[16:17], v20 offset:36992
  v_mfma_f32_16x16x32_bf16 v[48:51], a[0:3], a[32:35], v[48:51]
  ds_read_b64_tr_b16 a[18:19], v20 offset:38528
  v_mfma_f32_16x16x32_bf16 v[52:55], a[4:7], a[32:35], v[52:55]
  ds_read_b64_tr_b16 a[20:21], v20 offset:37120
  v_mfma_f32_16x16x32_bf16 v[56:59], a[8:11], a[32:35], v[56:59]
  ds_read_b64_tr_b16 a[22:23], v20 offset:38656
  v_mfma_f32_16x16x32_bf16 v[60:63], a[0:3], a[36:39], v[60:63]
  ds_read_b128 a[44:47], v15 offset:10240
  v_mfma_f32_16x16x32_bf16 v[64:67], a[4:7], a[36:39], v[64:67]
  ds_read_b128 a[48:51], v16 offset:10240
  v_mfma_f32_16x16x32_bf16 v[68:71], a[8:11], a[36:39], v[68:71]
  ds_read_b128 a[52:55], v17 offset:10240
  v_mfma_f32_16x16x32_bf16 v[72:75], a[0:3], a[40:43], v[72:75]
  ds_read_b128 a[56:59], v18 offset:10240
  v_mfma_f32_16x16x32_bf16 v[76:79], a[4:7], a[40:43], v[76:79]
  ds_read_b128 a[60:63], v19 offset:10240
  v_mfma_f32_16x16x32_bf16 v[80:83], a[8:11], a[40:43], v[80:83]
  v_mfma_f32_16x16x32_bf16 v[24:27], a[0:3], a[24:27], v[24:27]
  v_mfma_f32_16x16x32_bf16 v[28:31], a[4:7], a[24:27], v[28:31]
  v_mfma_f32_16x16x32_bf16 v[32:35], a[8:11], a[24:27], v[32:35]
  v_mfma_f32_16x16x32_bf16 v[84:87], a[24:27], a[24:27], v[84:87]
  v_mfma_f32_16x16x32_bf16 v[92:95], a[64:67], a[24:27], v[92:95]
  v_mfma_f32_16x16x32_bf16 v[88:91], a[28:31], a[28:31], v[88:91]
  v_mfma_f32_16x16x32_bf16 v[96:99], a[64:67], a[28:31], v[96:99]
  s_barrier
  s_waitcnt lgkmcnt(0)
  v_mfma_f32_16x16x32_bf16 v[36:39], a[12:15], a[48:51], v[36:39]
  ds_read_b64_tr_b16 a[0:1], v20 offset:49152
  v_mfma_f32_16x16x32_bf16 v[40:43], a[16:19], a[48:51], v[40:43]
  ds_read_b64_tr_b16 a[2:3], v20 offset:50688
  v_mfma_f32_16x16x32_bf16 v[44:47], a[20:23], a[48:51], v[44:47]
  ds_read_b64_tr_b16 a[4:5], v20 offset:49280
  v_mfma_f32_16x16x32_bf16 v[48:51], a[12:15], a[52:55], v[48:51]
  ds_read_b64_tr_b16 a[6:7], v20 offset:50816
  v_mfma_f32_16x16x32_bf16 v[52:55], a[16:19], a[52:55], v[52:55]
  ds_read_b64_tr_b16 a[8:9], v20 offset:49408
  v_mfma_f32_16x16x32_bf16 v[56:59], a[20:23], a[52:55], v[56:59]
  ds_read_b64_tr_b16 a[10:11], v20 offset:50944
  v_mfma_f32_16x16x32_bf16 v[60:63], a[12:15], a[56:59], v[60:63]
  ds_read_b128 a[24:27], v10 offset:20480
  v_mfma_f32_16x16x32_bf16 v[64:67], a[16:19], a[56:59], v[64:67]
  ds_read_b128 a[28:31], v11 offset:20480
  v_mfma_f32_16x16x32_bf16 v[68:71], a[20:23], a[56:59], v[68:71]
  ds_read_b128 a[32:35], v12 offset:20480
  v_mfma_f32_16x16x32_bf16 v[72:75], a[12:15], a[60:63], v[72:75]
  ds_read_b128 a[36:39], v13 offset:20480
  v_mfma_f32_16x16x32_bf16 v[76:79], a[16:19], a[60:63], v[76:79]
  ds_read_b128 a[40:43], v14 offset:20480
  v_mfma_f32_16x16x32_bf16 v[80:83], a[20:23], a[60:63], v[80:83]
  v_mfma_f32_16x16x32_bf16 v[24:27], a[12:15], a[44:47], v[24:27]
  v_mfma_f32_16x16x32_bf16 v[28:31], a[16:19], a[44:47], v[28:31]
  v_mfma_f32_16x16x32_bf16 v[32:35], a[20:23], a[44:47], v[32:35]
  v_mfma_f32_16x16x32_bf16 v[84:87], a[44:47], a[44:47], v[84:87]
  v_mfma_f32_16x16x32_bf16 v[92:95], a[64:67], a[44:47], v[92:95]
  v_mfma_f32_16x16x32_bf16 v[88:91], a[48:51], a[48:51], v[88:91]
  v_mfma_f32_16x16x32_bf16 v[96:99], a[64:67], a[48:51], v[96:99]
  s_barrier
  s_waitcnt lgkmcnt(0)
  v_mfma_f32_16x16x32_bf16 v[36:39], a[0:3], a[28:31], v[36:39]
  ds_read_b64_tr_b16 a[12:13], v21 offset:0
  v_mfma_f32_16x16x32_bf16 v[40:43], a[4:7], a[28:31], v[40:43]
  ds_read_b64_tr_b16 a[14:15], v21 offset:1536
  v_mfma_f32_16x16x32_bf16 v[44:47], a[8:11], a[28:31], v[44:47]
  ds_read_b64_tr_b16 a[16:17], v21 offset:128
  v_mfma_f32_16x16x32_bf16 v[48:51], a[0:3], a[32:35], v[48:51]
  ds_read_b64_tr_b16 a[18:19], v21 offset:1664
  v_mfma_f32_16x16x32_bf16 v[52:55], a[4:7], a[32:35], v[52:55]
  ds_read_b64_tr_b16 a[20:21], v21 offset:256
  v_mfma_f32_16x16x32_bf16 v[56:59], a[8:11], a[32:35], v[56:59]
  ds_read_b64_tr_b16 a[22:23], v21 offset:1792
  v_mfma_f32_16x16x32_bf16 v[60:63], a[0:3], a[36:39], v[60:63]
  ds_read_b128 a[44:47], v15 offset:20480
  v_mfma_f32_16x16x32_bf16 v[64:67], a[4:7], a[36:39], v[64:67]
  ds_read_b128 a[48:51], v16 offset:20480
  v_mfma_f32_16x16x32_bf16 v[68:71], a[8:11], a[36:39], v[68:71]
  ds_read_b128 a[52:55], v17 offset:20480
  v_mfma_f32_16x16x32_bf16 v[72:75], a[0:3], a[40:43], v[72:75]
  ds_read_b128 a[56:59], v18 offset:20480
  v_mfma_f32_16x16x32_bf16 v[76:79], a[4:7], a[40:43], v[76:79]
  ds_read_b128 a[60:63], v19 offset:20480
  v_mfma_f32_16x16x32_bf16 v[80:83], a[8:11], a[40:43], v[80:83]
  v_mfma_f32_16x16x32_bf16 v[24:27], a[0:3], a[24:27], v[24:27]
  v_mfma_f32_16x16x32_bf16 v[28:31], a[4:7], a[24:27], v[28:31]
  v_mfma_f32_16x16x32_bf16 v[32:35], a[8:11], a[24:27], v[32:35]
  v_mfma_f32_16x16x32_bf16 v[84:87], a[24:27], a[24:27], v[84:87]
  v_mfma_f32_16x16x32_bf16 v[92:95], a[64:67], a[24:27], v[92:95]
  v_mfma_f32_16x16x32_bf16 v[88:91], a[28:31], a[28:31], v[88:91]
  v_mfma_f32_16x16x32_bf16 v[96:99], a[64:67], a[28:31], v[96:99]
  s_barrier
  s_waitcnt lgkmcnt(0)
  v_mfma_f32_16x16x32_bf16 v[36:39], a[12:15], a[48:51], v[36:39]
  ds_read_b64_tr_b16 a[0:1], v21 offset:12288
  v_mfma_f32_16x16x32_bf16 v[40:43], a[16:19], a[48:51], v[40:43]
  ds_read_b64_tr_b16 a[2:3], v21 offset:13824
  v_mfma_f32_16x16x32_bf16 v[44:47], a[20:23], a[48:51], v[44:47]
  ds_read_b64_tr_b16 a[4:5], v21 offset:12416
  v_mfma_f32_16x16x32_bf16 v[48:51], a[12:15], a[52:55], v[48:51]
  ds_read_b64_tr_b16 a[6:7], v21 offset:13952
  v_mfma_f32_16x16x32_bf16 v[52:55], a[16:19], a[52:55], v[52:55]
  ds_read_b64_tr_b16 a[8:9], v21 offset:12544
  v_mfma_f32_16x16x32_bf16 v[56:59], a[20:23], a[52:55], v[56:59]
  ds_read_b64_tr_b16 a[10:11], v21 offset:14080
  v_mfma_f32_16x16x32_bf16 v[60:63], a[12:15], a[56:59], v[60:63]
  ds_read_b128 a[24:27], v10 offset:30720
  v_mfma_f32_16x16x32_bf16 v[64:67], a[16:19], a[56:59], v[64:67]
  ds_read_b128 a[28:31], v11 offset:30720
  v_mfma_f32_16x16x32_bf16 v[68:71], a[20:23], a[56:59], v[68:71]
  ds_read_b128 a[32:35], v12 offset:30720
  v_mfma_f32_16x16x32_bf16 v[72:75], a[12:15], a[60:63], v[72:75]
  ds_read_b128 a[36:39], v13 offset:30720
  v_mfma_f32_16x16x32_bf16 v[76:79], a[16:19], a[60:63], v[76:79]
  ds_read_b128 a[40:43], v14 offset:30720
  v_mfma_f32_16x16x32_bf16 v[80:83], a[20:23], a[60:63], v[80:83]
  v_mfma_f32_16x16x32_bf16 v[24:27], a[12:15], a[44:47], v[24:27]
  v_mfma_f32_16x16x32_bf16 v[28:31], a[16:19], a[44:47], v[28:31]
  v_mfma_f32_16x16x32_bf16 v[32:35], a[20:23], a[44:47], v[32:35]
  v_mfma_f32_16x16x32_bf16 v[84:87], a[44:47], a[44:47], v[84:87]
  v_mfma_f32_16x16x32_bf16 v[92:95], a[64:67], a[44:47], v[92:95]
  v_mfma_f32_16x16x32_bf16 v[88:91], a[48:51], a[48:51], v[88:91]
  v_mfma_f32_16x16x32_bf16 v[96:99], a[64:67], a[48:51], v[96:99]
  s_barrier
  s_waitcnt lgkmcnt(0)
  v_mfma_f32_16x16x32_bf16 v[36:39], a[0:3], a[28:31], v[36:39]
  ds_read_b64_tr_b16 a[12:13], v20 offset:0
  v_mfma_f32_16x16x32_bf16 v[40:43], a[4:7], a[28:31], v[40:43]
  ds_read_b64_tr_b16 a[14:15], v20 offset:1536
  v_mfma_f32_16x16x32_bf16 v[44:47], a[8:11], a[28:31], v[44:47]
  ds_read_b64_tr_b16 a[16:17], v20 offset:128
  v_mfma_f32_16x16x32_bf16 v[48:51], a[0:3], a[32:35], v[48:51]
  ds_read_b64_tr_b16 a[18:19], v20 offset:1664
  v_mfma_f32_16x16x32_bf16 v[52:55], a[4:7], a[32:35], v[52:55]
  ds_read_b64_tr_b16 a[20:21], v20 offset:256
  v_mfma_f32_16x16x32_bf16 v[56:59], a[8:11], a[32:35], v[56:59]
  ds_read_b64_tr_b16 a[22:23], v20 offset:1792
  v_mfma_f32_16x16x32_bf16 v[60:63], a[0:3], a[36:39], v[60:63]
  ds_read_b128 a[44:47], v15 offset:30720
  v_mfma_f32_16x16x32_bf16 v[64:67], a[4:7], a[36:39], v[64:67]
  ds_read_b128 a[48:51], v16 offset:30720
  v_mfma_f32_16x16x32_bf16 v[68:71], a[8:11], a[36:39], v[68:71]
  ds_read_b128 a[52:55], v17 offset:30720
  v_mfma_f32_16x16x32_bf16 v[72:75], a[0:3], a[40:43], v[72:75]
  ds_read_b128 a[56:59], v18 offset:30720
  v_mfma_f32_16x16x32_bf16 v[76:79], a[4:7], a[40:43], v[76:79]
  ds_read_b128 a[60:63], v19 offset:30720
  v_mfma_f32_16x16x32_bf16 v[80:83], a[8:11], a[40:43], v[80:83]
  v_mfma_f32_16x16x32_bf16 v[24:27], a[0:3], a[24:27], v[24:27]
  v_mfma_f32_16x16x32_bf16 v[28:31], a[4:7], a[24:27], v[28:31]
  v_mfma_f32_16x16x32_bf16 v[32:35], a[8:11], a[24:27], v[32:35]
  v_mfma_f32_16x16x32_bf16 v[84:87], a[24:27], a[24:27], v[84:87]
  v_mfma_f32_16x16x32_bf16 v[92:95], a[64:67], a[24:27], v[92:95]
  v_mfma_f32_16x16x32_bf16 v[88:91], a[28:31], a[28:31], v[88:91]
  v_mfma_f32_16x16x32_bf16 v[96:99], a[64:67], a[28:31], v[96:99]
  s_barrier
  s_waitcnt lgkmcnt(0)
  v_mfma_f32_16x16x32_bf16 v[36:39], a[12:15], a[48:51], v[36:39]
  ds_read_b64_tr_b16 a[0:1], v20 offset:12288
  v_mfma_f32_16x16x32_bf16 v[40:43], a[16:19], a[48:51], v[40:43]
  ds_read_b64_tr_b16 a[2:3], v20 offset:13824
  v_mfma_f32_16x16x32_bf16 v[44:47], a[20:23], a[48:51], v[44:47]
  ds_read_b64_tr_b16 a[4:5], v20 offset:12416
  v_mfma_f32_16x16x32_bf16 v[48:51], a[12:15], a[52:55], v[48:51]
  ds_read_b64_tr_b16 a[6:7], v20 offset:13952
  v_mfma_f32_16x16x32_bf16 v[52:55], a[16:19], a[52:55], v[52:55]
  ds_read_b64_tr_b16 a[8:9], v20 offset:12544
  v_mfma_f32_16x16x32_bf16 v[56:59], a[20:23], a[52:55], v[56:59]
  ds_read_b64_tr_b16 a[10:11], v20 offset:14080
  v_mfma_f32_16x16x32_bf16 v[60:63], a[12:15], a[56:59], v[60:63]
  ds_read_b128 a[24:27], v10 offset:40960
  v_mfma_f32_16x16x32_bf16 v[64:67], a[16:19], a[56:59], v[64:67]
  ds_read_b128 a[28:31], v11 offset:40960
  v_mfma_f32_16x16x32_bf16 v[68:71], a[20:23], a[56:59], v[68:71]
  ds_read_b128 a[32:35], v12 offset:40960
  v_mfma_f32_16x16x32_bf16 v[72:75], a[12:15], a[60:63], v[72:75]
  ds_read_b128 a[36:39], v13 offset:40960
  v_mfma_f32_16x16x32_bf16 v[76:79], a[16:19], a[60:63], v[76:79]
  ds_read_b128 a[40:43], v14 offset:40960
  v_mfma_f32_16x16x32_bf16 v[80:83], a[20:23], a[60:63], v[80:83]
  v_mfma_f32_16x16x32_bf16 v[24:27], a[12:15], a[44:47], v[24:27]
  v_mfma_f32_16x16x32_bf16 v[28:31], a[16:19], a[44:47], v[28:31]
  v_mfma_f32_16x16x32_bf16 v[32:35], a[20:23], a[44:47], v[32:35]
  v_mfma_f32_16x16x32_bf16 v[84:87], a[44:47], a[44:47], v[84:87]
  v_mfma_f32_16x16x32_bf16 v[92:95], a[64:67], a[44:47], v[92:95]
  v_mfma_f32_16x16x32_bf16 v[88:91], a[48:51], a[48:51], v[88:91]
  v_mfma_f32_16x16x32_bf16 v[96:99], a[64:67], a[48:51], v[96:99]
  s_barrier
  s_waitcnt lgkmcnt(0)
  v_mfma_f32_16x16x32_bf16 v[36:39], a[0:3], a[28:31], v[36:39]
  ds_read_b64_tr_b16 a[12:13], v20 offset:24576
  v_mfma_f32_16x16x32_bf16 v[40:43], a[4:7], a[28:31], v[40:43]
  ds_read_b64_tr_b16 a[14:15], v20 offset:26112
  v_mfma_f32_16x16x32_bf16 v[44:47], a[8:11], a[28:31], v[44:47]
  ds_read_b64_tr_b16 a[16:17], v20 offset:24704
  v_mfma_f32_16x16x32_bf16 v[48:51], a[0:3], a[32:35], v[48:51]
  ds_read_b64_tr_b16 a[18:19], v20 offset:26240
  v_mfma_f32_16x16x32_bf16 v[52:55], a[4:7], a[32:35], v[52:55]
  ds_read_b64_tr_b16 a[20:21], v20 offset:24832
  v_mfma_f32_16x16x32_bf16 v[56:59], a[8:11], a[32:35], v[56:59]
  ds_read_b64_tr_b16 a[22:23], v20 offset:26368
  v_mfma_f32_16x16x32_bf16 v[60:63], a[0:3], a[36:39], v[60:63]
  ds_read_b128 a[44:47], v15 offset:40960
  v_mfma_f32_16x16x32_bf16 v[64:67], a[4:7], a[36:39], v[64:67]
  ds_read_b128 a[48:51], v16 offset:40960
  v_mfma_f32_16x16x32_bf16 v[68:71], a[8:11], a[36:39], v[68:71]
  ds_read_b128 a[52:55], v17 offset:40960
  v_mfma_f32_16x16x32_bf16 v[72:75], a[0:3], a[40:43], v[72:75]
  ds_read_b128 a[56:59], v18 offset:40960
  v_mfma_f32_16x16x32_bf16 v[76:79], a[4:7], a[40:43], v[76:79]
  ds_read_b128 a[60:63], v19 offset:40960
  v_mfma_f32_16x16x32_bf16 v[80:83], a[8:11], a[40:43], v[80:83]
  v_mfma_f32_16x16x32_bf16 v[24:27], a[0:3], a[24:27], v[24:27]
  v_mfma_f32_16x16x32_bf16 v[28:31], a[4:7], a[24:27], v[28:31]
  v_mfma_f32_16x16x32_bf16 v[32:35], a[8:11], a[24:27], v[32:35]
  v_mfma_f32_16x16x32_bf16 v[84:87], a[24:27], a[24:27], v[84:87]
  v_mfma_f32_16x16x32_bf16 v[92:95], a[64:67], a[24:27], v[92:95]
  v_mfma_f32_16x16x32_bf16 v[88:91], a[28:31], a[28:31], v[88:91]
  v_mfma_f32_16x16x32_bf16 v[96:99], a[64:67], a[28:31], v[96:99]
  s_barrier
  s_waitcnt lgkmcnt(0)
  v_mfma_f32_16x16x32_bf16 v[36:39], a[12:15], a[48:51], v[36:39]
  ds_read_b64_tr_b16 a[0:1], v20 offset:36864
  v_mfma_f32_16x16x32_bf16 v[40:43], a[16:19], a[48:51], v[40:43]
  ds_read_b64_tr_b16 a[2:3], v20 offset:38400
  v_mfma_f32_16x16x32_bf16 v[44:47], a[20:23], a[48:51], v[44:47]
  ds_read_b64_tr_b16 a[4:5], v20 offset:36992
  v_mfma_f32_16x16x32_bf16 v[48:51], a[12:15], a[52:55], v[48:51]
  ds_read_b64_tr_b16 a[6:7], v20 offset:38528
  v_mfma_f32_16x16x32_bf16 v[52:55], a[16:19], a[52:55], v[52:55]
  ds_read_b64_tr_b16 a[8:9], v20 offset:37120
  v_mfma_f32_16x16x32_bf16 v[56:59], a[20:23], a[52:55], v[56:59]
  ds_read_b64_tr_b16 a[10:11], v20 offset:38656
  v_mfma_f32_16x16x32_bf16 v[60:63], a[12:15], a[56:59], v[60:63]
  ds_read_b128 a[24:27], v10 offset:51200
  v_mfma_f32_16x16x32_bf16 v[64:67], a[16:19], a[56:59], v[64:67]
  ds_read_b128 a[28:31], v11 offset:51200
  v_mfma_f32_16x16x32_bf16 v[68:71], a[20:23], a[56:59], v[68:71]
  ds_read_b128 a[32:35], v12 offset:51200
  v_mfma_f32_16x16x32_bf16 v[72:75], a[12:15], a[60:63], v[72:75]
  ds_read_b128 a[36:39], v13 offset:51200
  v_mfma_f32_16x16x32_bf16 v[76:79], a[16:19], a[60:63], v[76:79]
  ds_read_b128 a[40:43], v14 offset:51200
  v_mfma_f32_16x16x32_bf16 v[80:83], a[20:23], a[60:63], v[80:83]
  v_mfma_f32_16x16x32_bf16 v[24:27], a[12:15], a[44:47], v[24:27]
  v_mfma_f32_16x16x32_bf16 v[28:31], a[16:19], a[44:47], v[28:31]
  v_mfma_f32_16x16x32_bf16 v[32:35], a[20:23], a[44:47], v[32:35]
  v_mfma_f32_16x16x32_bf16 v[84:87], a[44:47], a[44:47], v[84:87]
  v_mfma_f32_16x16x32_bf16 v[92:95], a[64:67], a[44:47], v[92:95]
  v_mfma_f32_16x16x32_bf16 v[88:91], a[48:51], a[48:51], v[88:91]
  v_mfma_f32_16x16x32_bf16 v[96:99], a[64:67], a[48:51], v[96:99]
  s_barrier
  buffer_load_dword v140, v141, s[4:7], 0 offen sc0 sc1
  s_waitcnt lgkmcnt(0)
  v_mfma_f32_16x16x32_bf16 v[36:39], a[0:3], a[28:31], v[36:39]
  ds_read_b64_tr_b16 a[12:13], v20 offset:49152
  v_mfma_f32_16x16x32_bf16 v[40:43], a[4:7], a[28:31], v[40:43]
  ds_read_b64_tr_b16 a[14:15], v20 offset:50688
  v_mfma_f32_16x16x32_bf16 v[44:47], a[8:11], a[28:31], v[44:47]
  ds_read_b64_tr_b16 a[16:17], v20 offset:49280
  v_mfma_f32_16x16x32_bf16 v[48:51], a[0:3], a[32:35], v[48:51]
  ds_read_b64_tr_b16 a[18:19], v20 offset:50816
  v_mfma_f32_16x16x32_bf16 v[52:55], a[4:7], a[32:35], v[52:55]
  ds_read_b64_tr_b16 a[20:21], v20 offset:49408
  v_mfma_f32_16x16x32_bf16 v[56:59], a[8:11], a[32:35], v[56:59]
  ds_read_b64_tr_b16 a[22:23], v20 offset:50944
  v_mfma_f32_16x16x32_bf16 v[60:63], a[0:3], a[36:39], v[60:63]
  ds_read_b128 a[44:47], v15 offset:51200
  v_mfma_f32_16x16x32_bf16 v[64:67], a[4:7], a[36:39], v[64:67]
  ds_read_b128 a[48:51], v16 offset:51200
  v_mfma_f32_16x16x32_bf16 v[68:71], a[8:11], a[36:39], v[68:71]
  ds_read_b128 a[52:55], v17 offset:51200
  v_mfma_f32_16x16x32_bf16 v[72:75], a[0:3], a[40:43], v[72:75]
  ds_read_b128 a[56:59], v18 offset:51200
  v_mfma_f32_16x16x32_bf16 v[76:79], a[4:7], a[40:43], v[76:79]
  ds_read_b128 a[60:63], v19 offset:51200
  v_mfma_f32_16x16x32_bf16 v[80:83], a[8:11], a[40:43], v[80:83]
  v_mfma_f32_16x16x32_bf16 v[24:27], a[0:3], a[24:27], v[24:27]
  v_mfma_f32_16x16x32_bf16 v[28:31], a[4:7], a[24:27], v[28:31]
  v_mfma_f32_16x16x32_bf16 v[32:35], a[8:11], a[24:27], v[32:35]
  v_mfma_f32_16x16x32_bf16 v[84:87], a[24:27], a[24:27], v[84:87]
  v_mfma_f32_16x16x32_bf16 v[92:95], a[64:67], a[24:27], v[92:95]
  v_mfma_f32_16x16x32_bf16 v[88:91], a[28:31], a[28:31], v[88:91]
  v_mfma_f32_16x16x32_bf16 v[96:99], a[64:67], a[28:31], v[96:99]
  s_barrier
  s_waitcnt lgkmcnt(0)
  v_mfma_f32_16x16x32_bf16 v[36:39], a[12:15], a[48:51], v[36:39]
  ds_read_b64_tr_b16 a[0:1], v21 offset:0
  v_mfma_f32_16x16x32_bf16 v[40:43], a[16:19], a[48:51], v[40:43]
  ds_read_b64_tr_b16 a[2:3], v21 offset:1536
  v_mfma_f32_16x16x32_bf16 v[44:47], a[20:23], a[48:51], v[44:47]
  ds_read_b64_tr_b16 a[4:5], v21 offset:128
  v_mfma_f32_16x16x32_bf16 v[48:51], a[12:15], a[52:55], v[48:51]
  ds_read_b64_tr_b16 a[6:7], v21 offset:1664
  v_mfma_f32_16x16x32_bf16 v[52:55], a[16:19], a[52:55], v[52:55]
  ds_read_b64_tr_b16 a[8:9], v21 offset:256
  v_mfma_f32_16x16x32_bf16 v[56:59], a[20:23], a[52:55], v[56:59]
  ds_read_b64_tr_b16 a[10:11], v21 offset:1792
  v_mfma_f32_16x16x32_bf16 v[60:63], a[12:15], a[56:59], v[60:63]
  ds_read_b128 a[24:27], v10 offset:61440
  v_mfma_f32_16x16x32_bf16 v[64:67], a[16:19], a[56:59], v[64:67]
  ds_read_b128 a[28:31], v11 offset:61440
  v_mfma_f32_16x16x32_bf16 v[68:71], a[20:23], a[56:59], v[68:71]
  ds_read_b128 a[32:35], v12 offset:61440
  v_mfma_f32_16x16x32_bf16 v[72:75], a[12:15], a[60:63], v[72:75]
  ds_read_b128 a[36:39], v13 offset:61440
  v_mfma_f32_16x16x32_bf16 v[76:79], a[16:19], a[60:63], v[76:79]
  ds_read_b128 a[40:43], v14 offset:61440
  v_mfma_f32_16x16x32_bf16 v[80:83], a[20:23], a[60:63], v[80:83]
  v_mfma_f32_16x16x32_bf16 v[24:27], a[12:15], a[44:47], v[24:27]
  v_mfma_f32_16x16x32_bf16 v[28:31], a[16:19], a[44:47], v[28:31]
  v_mfma_f32_16x16x32_bf16 v[32:35], a[20:23], a[44:47], v[32:35]
  v_mfma_f32_16x16x32_bf16 v[84:87], a[44:47], a[44:47], v[84:87]
  v_mfma_f32_16x16x32_bf16 v[92:95], a[64:67], a[44:47], v[92:95]
  v_mfma_f32_16x16x32_bf16 v[88:91], a[48:51], a[48:51], v[88:91]
  v_mfma_f32_16x16x32_bf16 v[96:99], a[64:67], a[48:51], v[96:99]
  s_barrier
  s_waitcnt lgkmcnt(0)
  v_mfma_f32_16x16x32_bf16 v[36:39], a[0:3], a[28:31], v[36:39]
  ds_read_b64_tr_b16 a[12:13], v21 offset:12288
  v_mfma_f32_16x16x32_bf16 v[40:43], a[4:7], a[28:31], v[40:43]
  ds_read_b64_tr_b16 a[14:15], v21 offset:13824
  v_mfma_f32_16x16x32_bf16 v[44:47], a[8:11], a[28:31], v[44:47]
  ds_read_b64_tr_b16 a[16:17], v21 offset:12416
  v_mfma_f32_16x16x32_bf16 v[48:51], a[0:3], a[32:35], v[48:51]
  ds_read_b64_tr_b16 a[18:19], v21 offset:13952
  v_mfma_f32_16x16x32_bf16 v[52:55], a[4:7], a[32:35], v[52:55]
  ds_read_b64_tr_b16 a[20:21], v21 offset:12544
  v_mfma_f32_16x16x32_bf16 v[56:59], a[8:11], a[32:35], v[56:59]
  ds_read_b64_tr_b16 a[22:23], v21 offset:14080
  v_mfma_f32_16x16x32_bf16 v[60:63], a[0:3], a[36:39], v[60:63]
  ds_read_b128 a[44:47], v15 offset:61440
  v_mfma_f32_16x16x32_bf16 v[64:67], a[4:7], a[36:39], v[64:67]
  ds_read_b128 a[48:51], v16 offset:61440
  v_mfma_f32_16x16x32_bf16 v[68:71], a[8:11], a[36:39], v[68:71]
  ds_read_b128 a[52:55], v17 offset:61440
  v_mfma_f32_16x16x32_bf16 v[72:75], a[0:3], a[40:43], v[72:75]
  ds_read_b128 a[56:59], v18 offset:61440
  v_mfma_f32_16x16x32_bf16 v[76:79], a[4:7], a[40:43], v[76:79]
  ds_read_b128 a[60:63], v19 offset:61440
  v_mfma_f32_16x16x32_bf16 v[80:83], a[8:11], a[40:43], v[80:83]
  v_mfma_f32_16x16x32_bf16 v[24:27], a[0:3], a[24:27], v[24:27]
  v_mfma_f32_16x16x32_bf16 v[28:31], a[4:7], a[24:27], v[28:31]
  v_mfma_f32_16x16x32_bf16 v[32:35], a[8:11], a[24:27], v[32:35]
  v_mfma_f32_16x16x32_bf16 v[84:87], a[24:27], a[24:27], v[84:87]
  v_mfma_f32_16x16x32_bf16 v[92:95], a[64:67], a[24:27], v[92:95]
  v_mfma_f32_16x16x32_bf16 v[88:91], a[28:31], a[28:31], v[88:91]
  v_mfma_f32_16x16x32_bf16 v[96:99], a[64:67], a[28:31], v[96:99]
  s_waitcnt lgkmcnt(0)
  v_mfma_f32_16x16x32_bf16 v[36:39], a[12:15], a[48:51], v[36:39]
  v_mfma_f32_16x16x32_bf16 v[40:43], a[16:19], a[48:51], v[40:43]
  v_mfma_f32_16x16x32_bf16 v[44:47], a[20:23], a[48:51], v[44:47]
  v_mfma_f32_16x16x32_bf16 v[48:51], a[12:15], a[52:55], v[48:51]
  v_mfma_f32_16x16x32_bf16 v[52:55], a[16:19], a[52:55], v[52:55]
  v_mfma_f32_16x16x32_bf16 v[56:59], a[20:23], a[52:55], v[56:59]
  v_mfma_f32_16x16x32_bf16 v[60:63], a[12:15], a[56:59], v[60:63]
  v_mfma_f32_16x16x32_bf16 v[64:67], a[16:19], a[56:59], v[64:67]
  v_mfma_f32_16x16x32_bf16 v[68:71], a[20:23], a[56:59], v[68:71]
  v_mfma_f32_16x16x32_bf16 v[72:75], a[12:15], a[60:63], v[72:75]
  v_mfma_f32_16x16x32_bf16 v[76:79], a[16:19], a[60:63], v[76:79]
  v_mfma_f32_16x16x32_bf16 v[80:83], a[20:23], a[60:63], v[80:83]
  v_mfma_f32_16x16x32_bf16 v[24:27], a[12:15], a[44:47], v[24:27]
  v_mfma_f32_16x16x32_bf16 v[28:31], a[16:19], a[44:47], v[28:31]
  v_mfma_f32_16x16x32_bf16 v[32:35], a[20:23], a[44:47], v[32:35]
  v_mfma_f32_16x16x32_bf16 v[84:87], a[44:47], a[44:47], v[84:87]
  v_mfma_f32_16x16x32_bf16 v[92:95], a[64:67], a[44:47], v[92:95]
  v_mfma_f32_16x16x32_bf16 v[88:91], a[48:51], a[48:51], v[88:91]
  v_mfma_f32_16x16x32_bf16 v[96:99], a[64:67], a[48:51], v[96:99]
  s_lshl_b32 s56, s59, 7
  s_lshl_b32 s57, s60, 2
  s_add_u32 s12, s56, s57
  s_add_u32 s12, s12, 0xd80000
  s_nop 7
  v_cndmask_b32 v2, v84, v85, s[68:69]
  v_cndmask_b32 v3, v88, v89, s[68:69]
  v_cndmask_b32 v2, v2, v86, s[70:71]
  v_cndmask_b32 v3, v3, v90, s[70:71]
  v_cndmask_b32 v2, v2, v87, s[72:73]
  v_cndmask_b32 v3, v3, v91, s[72:73]
  v_cndmask_b32 v2, 0, v2, s[74:75]
  v_cndmask_b32 v3, 0, v3, s[74:75]
  v_mov_b32 v4, v2
  v_mov_b32 v5, v3
  s_nop 1
  v_permlane16_swap_b32 v4, v2
  v_permlane16_swap_b32 v5, v3
  s_nop 1
  v_add_f32 v2, v2, v4
  v_add_f32 v3, v3, v5
  v_mov_b32 v4, v2
  v_mov_b32 v5, v3
  s_nop 1
  v_permlane32_swap_b32 v4, v2
  v_permlane32_swap_b32 v5, v3
  v_mul_f32 v6, 0x3b124925, v92
  v_mul_f32 v7, 0x3b124925, v96
  v_add_f32 v2, v2, v4
  v_add_f32 v3, v3, v5
  v_mul_f32 v2, 0x3b124925, v2
  v_mul_f32 v3, 0x3b124925, v3
  v_fma_f32 v2, -v6, v6, v2
  v_fma_f32 v3, -v7, v7, v3
  v_max_f32 v2, 0, v2
  v_max_f32 v3, 0, v3
  v_add_f32 v2, 0x3727c5ac, v2
  v_add_f32 v3, 0x3727c5ac, v3
  v_rsq_f32 v10, v2
  v_rsq_f32 v12, v3
  s_nop 0
  v_mul_f32 v11, v6, v10
  v_mul_f32 v13, v7, v12
  v_sub_f32 v11, 0, v11
  v_sub_f32 v13, 0, v13
  ds_write_b64 v106, v[12:13]
  v_mov_b32_dpp v84, v24 row_newbcast:0 row_mask:0xf bank_mask:0xf
  v_mov_b32_dpp v85, v25 row_newbcast:0 row_mask:0xf bank_mask:0xf
  v_mov_b32_dpp v86, v26 row_newbcast:0 row_mask:0xf bank_mask:0xf
  v_mov_b32_dpp v87, v27 row_newbcast:0 row_mask:0xf bank_mask:0xf
  v_mov_b32_dpp v88, v28 row_newbcast:0 row_mask:0xf bank_mask:0xf
  v_mov_b32_dpp v89, v29 row_newbcast:0 row_mask:0xf bank_mask:0xf
  v_mov_b32_dpp v90, v30 row_newbcast:0 row_mask:0xf bank_mask:0xf
  v_mov_b32_dpp v91, v31 row_newbcast:0 row_mask:0xf bank_mask:0xf
  v_mov_b32_dpp v92, v32 row_newbcast:0 row_mask:0xf bank_mask:0xf
  v_mov_b32_dpp v93, v33 row_newbcast:0 row_mask:0xf bank_mask:0xf
  v_mov_b32_dpp v94, v34 row_newbcast:0 row_mask:0xf bank_mask:0xf
  v_mov_b32_dpp v95, v35 row_newbcast:0 row_mask:0xf bank_mask:0xf
  s_waitcnt lgkmcnt(0)
  s_barrier
  ds_read_b64 v[14:15], v107
  ds_read_b64 v[16:17], v108
  ds_read_b64 v[18:19], v109
  v_mul_f32 v12, v12, v105
  v_mul_f32 v13, v13, v105
  v_pk_mul_f32 v[36:37], v[36:37], v[12:13] op_sel_hi:[1,0]
  v_pk_mul_f32 v[38:39], v[38:39], v[12:13] op_sel_hi:[1,0]
  v_pk_mul_f32 v[40:41], v[40:41], v[12:13] op_sel_hi:[1,0]
  v_pk_mul_f32 v[42:43], v[42:43], v[12:13] op_sel_hi:[1,0]
  v_pk_mul_f32 v[44:45], v[44:45], v[12:13] op_sel_hi:[1,0]
  v_pk_mul_f32 v[46:47], v[46:47], v[12:13] op_sel_hi:[1,0]
  v_pk_fma_f32 v[36:37], v[84:85], v[12:13], v[36:37] op_sel:[0,1,0] op_sel_hi:[1,1,1]
  v_pk_fma_f32 v[38:39], v[86:87], v[12:13], v[38:39] op_sel:[0,1,0] op_sel_hi:[1,1,1]
  v_pk_fma_f32 v[40:41], v[88:89], v[12:13], v[40:41] op_sel:[0,1,0] op_sel_hi:[1,1,1]
  v_pk_fma_f32 v[42:43], v[90:91], v[12:13], v[42:43] op_sel:[0,1,0] op_sel_hi:[1,1,1]
  v_pk_fma_f32 v[44:45], v[92:93], v[12:13], v[44:45] op_sel:[0,1,0] op_sel_hi:[1,1,1]
  v_pk_fma_f32 v[46:47], v[94:95], v[12:13], v[46:47] op_sel:[0,1,0] op_sel_hi:[1,1,1]
  v_cvt_pk_bf16_f32 v2, v36, v37
  v_cvt_pk_bf16_f32 v3, v38, v39
  ds_write_b64 v101, v[2:3] offset:0
  v_cvt_pk_bf16_f32 v4, v40, v41
  v_cvt_pk_bf16_f32 v5, v42, v43
  ds_write_b64 v101, v[4:5] offset:128
  v_cvt_pk_bf16_f32 v6, v44, v45
  v_cvt_pk_bf16_f32 v7, v46, v47
  ds_write_b64 v101, v[6:7] offset:256
  v_mul_f32 v10, v10, v105
  v_mul_f32 v11, v11, v105
  v_pk_mul_f32 v[28:29], v[28:29], v[10:11] op_sel_hi:[1,0]
  v_pk_mul_f32 v[30:31], v[30:31], v[10:11] op_sel_hi:[1,0]
  v_pk_mul_f32 v[32:33], v[32:33], v[10:11] op_sel_hi:[1,0]
  v_pk_mul_f32 v[34:35], v[34:35], v[10:11] op_sel_hi:[1,0]
  v_pk_fma_f32 v[28:29], v[88:89], v[10:11], v[28:29] op_sel:[0,1,0] op_sel_hi:[1,1,1]
  v_pk_fma_f32 v[30:31], v[90:91], v[10:11], v[30:31] op_sel:[0,1,0] op_sel_hi:[1,1,1]
  v_pk_fma_f32 v[32:33], v[92:93], v[10:11], v[32:33] op_sel:[0,1,0] op_sel_hi:[1,1,1]
  v_pk_fma_f32 v[34:35], v[94:95], v[10:11], v[34:35] op_sel:[0,1,0] op_sel_hi:[1,1,1]
  v_cvt_pk_bf16_f32 v8, v28, v29
  v_cvt_pk_bf16_f32 v9, v30, v31
  ds_write_b64 v100, v[8:9] offset:128
  v_cvt_pk_bf16_f32 v2, v32, v33
  v_cvt_pk_bf16_f32 v3, v34, v35
  ds_write_b64 v100, v[2:3] offset:256
  s_waitcnt lgkmcnt(7)
  v_mul_f32 v14, v14, v105
  v_mul_f32 v15, v15, v105
  v_pk_mul_f32 v[48:49], v[48:49], v[14:15] op_sel_hi:[1,0]
  v_pk_mul_f32 v[50:51], v[50:51], v[14:15] op_sel_hi:[1,0]
  v_pk_mul_f32 v[52:53], v[52:53], v[14:15] op_sel_hi:[1,0]
  v_pk_mul_f32 v[54:55], v[54:55], v[14:15] op_sel_hi:[1,0]
  v_pk_mul_f32 v[56:57], v[56:57], v[14:15] op_sel_hi:[1,0]
  v_pk_mul_f32 v[58:59], v[58:59], v[14:15] op_sel_hi:[1,0]
  v_pk_fma_f32 v[48:49], v[84:85], v[14:15], v[48:49] op_sel:[0,1,0] op_sel_hi:[1,1,1]
  v_pk_fma_f32 v[50:51], v[86:87], v[14:15], v[50:51] op_sel:[0,1,0] op_sel_hi:[1,1,1]
  v_pk_fma_f32 v[52:53], v[88:89], v[14:15], v[52:53] op_sel:[0,1,0] op_sel_hi:[1,1,1]
  v_pk_fma_f32 v[54:55], v[90:91], v[14:15], v[54:55] op_sel:[0,1,0] op_sel_hi:[1,1,1]
  v_pk_fma_f32 v[56:57], v[92:93], v[14:15], v[56:57] op_sel:[0,1,0] op_sel_hi:[1,1,1]
  v_pk_fma_f32 v[58:59], v[94:95], v[14:15], v[58:59] op_sel:[0,1,0] op_sel_hi:[1,1,1]
  v_cvt_pk_bf16_f32 v4, v48, v49
  v_cvt_pk_bf16_f32 v5, v50, v51
  ds_write_b64 v102, v[4:5] offset:0
  v_cvt_pk_bf16_f32 v6, v52, v53
  v_cvt_pk_bf16_f32 v7, v54, v55
  ds_write_b64 v102, v[6:7] offset:128
  v_cvt_pk_bf16_f32 v8, v56, v57
  v_cvt_pk_bf16_f32 v9, v58, v59
  ds_write_b64 v102, v[8:9] offset:256
  s_waitcnt lgkmcnt(9)
  v_mul_f32 v16, v16, v105
  v_mul_f32 v17, v17, v105
  v_pk_mul_f32 v[60:61], v[60:61], v[16:17] op_sel_hi:[1,0]
  v_pk_mul_f32 v[62:63], v[62:63], v[16:17] op_sel_hi:[1,0]
  v_pk_mul_f32 v[64:65], v[64:65], v[16:17] op_sel_hi:[1,0]
  v_pk_mul_f32 v[66:67], v[66:67], v[16:17] op_sel_hi:[1,0]
  v_pk_mul_f32 v[68:69], v[68:69], v[16:17] op_sel_hi:[1,0]
  v_pk_mul_f32 v[70:71], v[70:71], v[16:17] op_sel_hi:[1,0]
  v_pk_fma_f32 v[60:61], v[84:85], v[16:17], v[60:61] op_sel:[0,1,0] op_sel_hi:[1,1,1]
  v_pk_fma_f32 v[62:63], v[86:87], v[16:17], v[62:63] op_sel:[0,1,0] op_sel_hi:[1,1,1]
  v_pk_fma_f32 v[64:65], v[88:89], v[16:17], v[64:65] op_sel:[0,1,0] op_sel_hi:[1,1,1]
  v_pk_fma_f32 v[66:67], v[90:91], v[16:17], v[66:67] op_sel:[0,1,0] op_sel_hi:[1,1,1]
  v_pk_fma_f32 v[68:69], v[92:93], v[16:17], v[68:69] op_sel:[0,1,0] op_sel_hi:[1,1,1]
  v_pk_fma_f32 v[70:71], v[94:95], v[16:17], v[70:71] op_sel:[0,1,0] op_sel_hi:[1,1,1]
  v_cvt_pk_bf16_f32 v2, v60, v61
  v_cvt_pk_bf16_f32 v3, v62, v63
  ds_write_b64 v103, v[2:3] offset:0
  v_cvt_pk_bf16_f32 v4, v64, v65
  v_cvt_pk_bf16_f32 v5, v66, v67
  ds_write_b64 v103, v[4:5] offset:128
  v_cvt_pk_bf16_f32 v6, v68, v69
  v_cvt_pk_bf16_f32 v7, v70, v71
  ds_write_b64 v103, v[6:7] offset:256
  s_waitcnt lgkmcnt(11)
  v_mul_f32 v18, v18, v105
  v_mul_f32 v19, v19, v105
  v_pk_mul_f32 v[72:73], v[72:73], v[18:19] op_sel_hi:[1,0]
  v_pk_mul_f32 v[74:75], v[74:75], v[18:19] op_sel_hi:[1,0]
  v_pk_mul_f32 v[76:77], v[76:77], v[18:19] op_sel_hi:[1,0]
  v_pk_mul_f32 v[78:79], v[78:79], v[18:19] op_sel_hi:[1,0]
  v_pk_mul_f32 v[80:81], v[80:81], v[18:19] op_sel_hi:[1,0]
  v_pk_mul_f32 v[82:83], v[82:83], v[18:19] op_sel_hi:[1,0]
  v_pk_fma_f32 v[72:73], v[84:85], v[18:19], v[72:73] op_sel:[0,1,0] op_sel_hi:[1,1,1]
  v_pk_fma_f32 v[74:75], v[86:87], v[18:19], v[74:75] op_sel:[0,1,0] op_sel_hi:[1,1,1]
  v_pk_fma_f32 v[76:77], v[88:89], v[18:19], v[76:77] op_sel:[0,1,0] op_sel_hi:[1,1,1]
  v_pk_fma_f32 v[78:79], v[90:91], v[18:19], v[78:79] op_sel:[0,1,0] op_sel_hi:[1,1,1]
  v_pk_fma_f32 v[80:81], v[92:93], v[18:19], v[80:81] op_sel:[0,1,0] op_sel_hi:[1,1,1]
  v_pk_fma_f32 v[82:83], v[94:95], v[18:19], v[82:83] op_sel:[0,1,0] op_sel_hi:[1,1,1]
  v_cvt_pk_bf16_f32 v8, v72, v73
  v_cvt_pk_bf16_f32 v9, v74, v75
  ds_write_b64 v104, v[8:9] offset:0
  v_cvt_pk_bf16_f32 v2, v76, v77
  v_cvt_pk_bf16_f32 v3, v78, v79
  ds_write_b64 v104, v[2:3] offset:128
  v_cvt_pk_bf16_f32 v4, v80, v81
  v_cvt_pk_bf16_f32 v5, v82, v83
  ds_write_b64 v104, v[4:5] offset:256
  s_waitcnt lgkmcnt(0)
  s_barrier
  ds_read_b128 v[24:27], v126 offset:0
  ds_read_b128 v[28:31], v127 offset:0
  ds_read_b128 v[32:35], v128
  ds_read_b128 v[60:63], v126 offset:12800
  ds_read_b128 v[64:67], v127 offset:12800
  ds_read_b128 v[68:71], v131
  ds_read_b64_tr_b16 v[36:37], v129 offset:0
  ds_read_b64_tr_b16 v[38:39], v130 offset:0
  ds_read_b64_tr_b16 v[40:41], v129 offset:32
  ds_read_b64_tr_b16 v[42:43], v130 offset:32
  ds_read_b64_tr_b16 v[72:73], v129 offset:12800
  ds_read_b64_tr_b16 v[74:75], v132 offset:0
  ds_read_b64_tr_b16 v[76:77], v129 offset:12832
  ds_read_b64_tr_b16 v[78:79], v132 offset:32
  s_waitcnt lgkmcnt(11)
  v_mfma_f32_16x16x32_bf16 v[44:47], v[28:31], v[24:27], 0
  v_mfma_f32_16x16x32_bf16 v[48:51], v[32:35], v[24:27], 0
  s_waitcnt lgkmcnt(8)
  v_mfma_f32_16x16x32_bf16 v[80:83], v[64:67], v[60:63], 0
  v_mfma_f32_16x16x32_bf16 v[84:87], v[68:71], v[60:63], 0
  s_nop 7
  v_fma_f32 v44, v44, s64, v110
  v_fma_f32 v45, v45, s64, v111
  v_fma_f32 v46, v46, s64, v112
  v_fma_f32 v47, v47, s64, v113
  v_fma_f32 v48, v48, s64, v114
  v_fma_f32 v49, v49, s64, v115
  v_fma_f32 v50, v50, s64, v116
  v_fma_f32 v51, v51, s64, v117
  v_fma_f32 v80, v80, s64, v118
  v_fma_f32 v81, v81, s64, v119
  v_fma_f32 v82, v82, s64, v120
  v_fma_f32 v83, v83, s64, v121
  v_fma_f32 v84, v84, s64, v122
  v_fma_f32 v85, v85, s64, v123
  v_fma_f32 v86, v86, s64, v124
  v_fma_f32 v87, v87, s64, v125
  v_max3_f32 v96, v44, v45, v46
  v_max3_f32 v97, v47, v48, v49
  v_max3_f32 v10, v80, v81, v82
  v_max3_f32 v11, v83, v84, v85
  v_max3_f32 v96, v96, v50, v51
  v_max3_f32 v10, v10, v86, v87
  v_max_f32 v96, v96, v97
  v_max_f32 v10, v10, v11
  v_mov_b32 v97, v96
  v_mov_b32 v11, v10
  s_nop 1
  v_permlane16_swap_b32 v96, v97
  v_permlane16_swap_b32 v10, v11
  s_nop 1
  v_max_f32 v96, v96, v97
  v_max_f32 v10, v10, v11
  v_mov_b32 v97, v96
  v_mov_b32 v11, v10
  s_nop 1
  v_permlane32_swap_b32 v96, v97
  v_permlane32_swap_b32 v10, v11
  s_nop 1
  v_max_f32 v96, v96, v97
  v_max_f32 v10, v10, v11
  v_sub_f32 v44, v44, v96
  v_sub_f32 v45, v45, v96
  v_sub_f32 v46, v46, v96
  v_sub_f32 v47, v47, v96
  v_sub_f32 v48, v48, v96
  v_sub_f32 v49, v49, v96
  v_sub_f32 v50, v50, v96
  v_sub_f32 v51, v51, v96
  v_sub_f32 v80, v80, v10
  v_sub_f32 v81, v81, v10
  v_sub_f32 v82, v82, v10
  v_sub_f32 v83, v83, v10
  v_sub_f32 v84, v84, v10
  v_sub_f32 v85, v85, v10
  v_sub_f32 v86, v86, v10
  v_sub_f32 v87, v87, v10
  v_exp_f32 v44, v44
  v_exp_f32 v45, v45
  v_exp_f32 v46, v46
  v_exp_f32 v47, v47
  v_exp_f32 v48, v48
  v_exp_f32 v49, v49
  v_exp_f32 v50, v50
  v_exp_f32 v51, v51
  v_exp_f32 v80, v80
  v_exp_f32 v81, v81
  v_exp_f32 v82, v82
  v_exp_f32 v83, v83
  v_exp_f32 v84, v84
  v_exp_f32 v85, v85
  v_exp_f32 v86, v86
  v_exp_f32 v87, v87
  v_add_f32 v98, v44, v45
  v_add_f32 v99, v46, v47
  v_add_f32 v12, v80, v81
  v_add_f32 v13, v82, v83
  v_add_f32 v98, v98, v48
  v_add_f32 v99, v99, v49
  v_add_f32 v12, v12, v84
  v_add_f32 v13, v13, v85
  v_add_f32 v98, v98, v50
  v_add_f32 v99, v99, v51
  v_add_f32 v12, v12, v86
  v_add_f32 v13, v13, v87
  v_add_f32 v98, v98, v99
  v_add_f32 v12, v12, v13
  v_mov_b32 v99, v98
  v_mov_b32 v13, v12
  s_nop 1
  v_permlane16_swap_b32 v98, v99
  v_permlane16_swap_b32 v12, v13
  s_nop 1
  v_add_f32 v98, v98, v99
  v_add_f32 v12, v12, v13
  v_mov_b32 v99, v98
  v_mov_b32 v13, v12
  s_nop 1
  v_permlane32_swap_b32 v98, v99
  v_permlane32_swap_b32 v12, v13
  s_nop 1
  v_add_f32 v98, v98, v99
  v_add_f32 v12, v12, v13
  v_rcp_f32 v98, v98
  v_rcp_f32 v12, v12
  s_nop 0
  v_mul_f32 v44, v44, v98
  v_mul_f32 v45, v45, v98
  v_mul_f32 v46, v46, v98
  v_mul_f32 v47, v47, v98
  v_mul_f32 v48, v48, v98
  v_mul_f32 v49, v49, v98
  v_mul_f32 v50, v50, v98
  v_mul_f32 v51, v51, v98
  v_mul_f32 v80, v80, v12
  v_mul_f32 v81, v81, v12
  v_mul_f32 v82, v82, v12
  v_mul_f32 v83, v83, v12
  v_mul_f32 v84, v84, v12
  v_mul_f32 v85, v85, v12
  v_mul_f32 v86, v86, v12
  v_mul_f32 v87, v87, v12
  v_cvt_pk_bf16_f32 v24, v44, v45
  v_cvt_pk_bf16_f32 v25, v46, v47
  v_cvt_pk_bf16_f32 v26, v48, v49
  v_cvt_pk_bf16_f32 v27, v50, v51
  v_cvt_pk_bf16_f32 v60, v80, v81
  v_cvt_pk_bf16_f32 v61, v82, v83
  v_cvt_pk_bf16_f32 v62, v84, v85
  v_cvt_pk_bf16_f32 v63, v86, v87
  s_nop 1
  s_waitcnt lgkmcnt(4)
  v_mfma_f32_16x16x32_bf16 v[52:55], v[36:39], v[24:27], 0
  v_mfma_f32_16x16x32_bf16 v[56:59], v[40:43], v[24:27], 0
  s_waitcnt lgkmcnt(0)
  v_mfma_f32_16x16x32_bf16 v[88:91], v[72:75], v[60:63], 0
  v_mfma_f32_16x16x32_bf16 v[92:95], v[76:79], v[60:63], 0
  s_nop 7
  v_cvt_pk_bf16_f32 v28, v52, v53
  v_cvt_pk_bf16_f32 v29, v54, v55
  ds_write_b64 v133, v[28:29] offset:0
  v_cvt_pk_bf16_f32 v30, v56, v57
  v_cvt_pk_bf16_f32 v31, v58, v59
  ds_write_b64 v134, v[30:31] offset:0
  v_cvt_pk_bf16_f32 v64, v88, v89
  v_cvt_pk_bf16_f32 v65, v90, v91
  ds_write_b64 v133, v[64:65] offset:4608
  v_cvt_pk_bf16_f32 v66, v92, v93
  v_cvt_pk_bf16_f32 v67, v94, v95
  ds_write_b64 v134, v[66:67] offset:4608
  s_waitcnt lgkmcnt(0)
  s_barrier
  ds_read_b128 v[24:27], v135
  ds_read_b128 v[28:31], v135 offset:64
  s_waitcnt lgkmcnt(1)
  buffer_store_dwordx4 v[24:27], v136, s[24:27], s65 offen sc1
  s_waitcnt lgkmcnt(0)
  s_cmp_eq_u32 s52, 3
  s_cbranch_scc1 Los_11
  buffer_store_dwordx4 v[28:31], v136, s[24:27], s65 offen offset:2048 sc1
Los_11:
  s_waitcnt vmcnt(0)
  v_cmp_ne_u32 vcc, 0, v140
  s_cbranch_vccnz Ltz_12
  s_mov_b32 s58, 0
Ltagw_14:
  buffer_load_dword v140, v141, s[4:7], 0 offen sc0 sc1
  s_add_u32 s58, s58, 1
  s_cmp_gt_u32 s58, 0x40000
  s_cbranch_scc1 Ltagok_13
  s_waitcnt vmcnt(0)
  v_cmp_eq_u32 vcc, 0, v140
  s_cbranch_vccnz Ltagw_14
Ltagok_13:
Ltz_12:
  s_barrier
  s_cmp_lg_u32 s52, 0
  s_cbranch_scc1 Lpub_15
  s_add_u32 s56, s12, 0x8000
  buffer_store_dword v140, v141, s[24:27], s56 offen
  buffer_store_dword v140, v141, s[24:27], s12 offen sc0 sc1
Lpub_15:
  s_cmp_ge_u32 s54, 28
  s_cbranch_scc1 Lc_job
  s_mul_i32 s56, s54, 9363
  s_lshr_b32 s56, s56, 16
  s_mul_i32 s57, s56, 7
  s_sub_u32 s60, s54, s57
  s_lshl_b32 s59, s53, 2
  s_add_u32 s59, s59, s56
  s_and_b32 s61, s52, 1
  s_lshr_b32 s62, s52, 1
  v_lshlrev_b32 v5, 4, v1
  v_lshrrev_b32 v6, 5, v1
  v_and_b32 v7, 31, v1
  s_lshl_b32 s56, s59, 6
  s_lshl_b32 s57, s62, 5
  s_add_u32 s65, s56, s57
  s_mul_i32 s56, s65, 896
  s_lshl_b32 s57, s60, 7
  s_add_u32 s56, s56, s57
  s_lshl_b32 s57, s61, 6
  s_add_u32 s64, s56, s57
  s_lshl_b32 s56, s59, 1
  s_add_u32 s56, s56, s62
  s_mul_i32 s56, s56, 28
  s_lshl_b32 s57, s60, 2
  s_add_u32 s56, s56, s57
  s_lshl_b32 s57, s61, 1
  s_add_u32 s56, s56, s57
  s_lshl_b32 s56, s56, 10
  s_add_u32 s63, s56, 0x200000
  s_lshl_b32 s56, s62, 12
  v_add_u32 v16, s56, v5
  v_and_b32 v2, 15, v1
  v_lshrrev_b32 v2, 2, v2
  v_lshlrev_b32 v3, 3, v6
  v_add_u32 v3, v3, v2
  v_lshlrev_b32 v19, 7, v3
  v_bfe_u32 v3, v1, 4, 1
  s_lshl_b32 s56, s61, 1
  v_add_u32 v3, s56, v3
  v_and_b32 v2, 2, v2
  v_xor_b32 v3, v3, v2
  v_lshlrev_b32 v3, 5, v3
  v_add_u32 v19, v19, v3
  v_and_b32 v2, 3, v1
  v_lshlrev_b32 v2, 3, v2
  v_add_u32 v19, v19, v2
  v_add_u32 v17, 0x10000, v16
  v_add_u32 v20, 0x10000, v19
  v_add_u32 v18, 0x20000, v16
  v_add_u32 v21, 0x20000, v19
  v_mul_u32_u24 v2, 896, v7
  v_lshlrev_b32 v3, 3, v6
  v_add_u32 v2, v2, v3
  buffer_load_dwordx2 v[8:9], v2, s[28:31], s64 offen offset:0
  buffer_load_dwordx2 v[10:11], v2, s[28:31], s64 offen offset:16
  buffer_load_dwordx2 v[12:13], v2, s[28:31], s64 offen offset:32
  buffer_load_dwordx2 v[14:15], v2, s[28:31], s64 offen offset:48
  s_waitcnt vmcnt(0)
  v_lshlrev_b32 v24, 16, v8
  v_and_b32 v25, 0xffff0000, v8
  v_lshlrev_b32 v26, 16, v9
  v_and_b32 v27, 0xffff0000, v9
  v_lshlrev_b32 v28, 16, v10
  v_and_b32 v29, 0xffff0000, v10
  v_lshlrev_b32 v30, 16, v11
  v_and_b32 v31, 0xffff0000, v11
  v_lshlrev_b32 v32, 16, v12
  v_and_b32 v33, 0xffff0000, v12
  v_lshlrev_b32 v34, 16, v13
  v_and_b32 v35, 0xffff0000, v13
  v_lshlrev_b32 v36, 16, v14
  v_and_b32 v37, 0xffff0000, v14
  v_lshlrev_b32 v38, 16, v15
  v_and_b32 v39, 0xffff0000, v15
  s_barrier
  ds_read_b128 v[44:47], v16 offset:0
  ds_read_b64_tr_b16 v[40:41], v20 offset:6144
  ds_read_b64_tr_b16 v[42:43], v20 offset:6656
  ds_read_b128 v[52:55], v16 offset:1024
  ds_read_b64_tr_b16 v[48:49], v20 offset:8192
  ds_read_b64_tr_b16 v[50:51], v20 offset:8704
  ds_read_b128 v[60:63], v16 offset:2048
  ds_read_b64_tr_b16 v[56:57], v20 offset:10240
  ds_read_b64_tr_b16 v[58:59], v20 offset:10752
  ds_read_b128 v[68:71], v16 offset:3072
  ds_read_b64_tr_b16 v[64:65], v20 offset:12288
  ds_read_b64_tr_b16 v[66:67], v20 offset:12800
  s_barrier
  s_waitcnt lgkmcnt(9)
  v_mfma_f32_32x32x16_bf16 v[24:39], v[40:43], v[44:47], v[24:39]
  ds_read_b128 v[76:79], v16 offset:8192
  ds_read_b64_tr_b16 v[72:73], v20 offset:14336
  ds_read_b64_tr_b16 v[74:75], v20 offset:14848
  s_waitcnt lgkmcnt(9)
  v_mfma_f32_32x32x16_bf16 v[24:39], v[48:51], v[52:55], v[24:39]
  ds_read_b128 v[84:87], v16 offset:9216
  ds_read_b64_tr_b16 v[80:81], v20 offset:16384
  ds_read_b64_tr_b16 v[82:83], v20 offset:16896
  s_waitcnt lgkmcnt(9)
  v_mfma_f32_32x32x16_bf16 v[24:39], v[56:59], v[60:63], v[24:39]
  ds_read_b128 v[92:95], v16 offset:10240
  ds_read_b64_tr_b16 v[88:89], v20 offset:18432
  ds_read_b64_tr_b16 v[90:91], v20 offset:18944
  s_waitcnt lgkmcnt(9)
  v_mfma_f32_32x32x16_bf16 v[24:39], v[64:67], v[68:71], v[24:39]
  ds_read_b128 v[100:103], v16 offset:11264
  ds_read_b64_tr_b16 v[96:97], v20 offset:20480
  ds_read_b64_tr_b16 v[98:99], v20 offset:20992
  s_barrier
  s_waitcnt lgkmcnt(9)
  v_mfma_f32_32x32x16_bf16 v[24:39], v[72:75], v[76:79], v[24:39]
  ds_read_b128 v[44:47], v16 offset:16384
  ds_read_b64_tr_b16 v[40:41], v20 offset:22528
  ds_read_b64_tr_b16 v[42:43], v20 offset:23040
  s_waitcnt lgkmcnt(9)
  v_mfma_f32_32x32x16_bf16 v[24:39], v[80:83], v[84:87], v[24:39]
  ds_read_b128 v[52:55], v16 offset:17408
  ds_read_b64_tr_b16 v[48:49], v20 offset:24576
  ds_read_b64_tr_b16 v[50:51], v20 offset:25088
  s_waitcnt lgkmcnt(9)
  v_mfma_f32_32x32x16_bf16 v[24:39], v[88:91], v[92:95], v[24:39]
  ds_read_b128 v[60:63], v16 offset:18432
  ds_read_b64_tr_b16 v[56:57], v20 offset:26624
  ds_read_b64_tr_b16 v[58:59], v20 offset:27136
  s_waitcnt lgkmcnt(9)
  v_mfma_f32_32x32x16_bf16 v[24:39], v[96:99], v[100:103], v[24:39]
  ds_read_b128 v[68:71], v16 offset:19456
  ds_read_b64_tr_b16 v[64:65], v20 offset:28672
  ds_read_b64_tr_b16 v[66:67], v20 offset:29184
  s_barrier
  s_waitcnt lgkmcnt(9)
  v_mfma_f32_32x32x16_bf16 v[24:39], v[40:43], v[44:47], v[24:39]
  ds_read_b128 v[76:79], v16 offset:24576
  ds_read_b64_tr_b16 v[72:73], v20 offset:30720
  ds_read_b64_tr_b16 v[74:75], v20 offset:31232
  s_waitcnt lgkmcnt(9)
  v_mfma_f32_32x32x16_bf16 v[24:39], v[48:51], v[52:55], v[24:39]
  ds_read_b128 v[84:87], v16 offset:25600
  ds_read_b64_tr_b16 v[80:81], v20 offset:32768
  ds_read_b64_tr_b16 v[82:83], v20 offset:33280
  s_waitcnt lgkmcnt(9)
  v_mfma_f32_32x32x16_bf16 v[24:39], v[56:59], v[60:63], v[24:39]
  ds_read_b128 v[92:95], v16 offset:26624
  ds_read_b64_tr_b16 v[88:89], v20 offset:34816
  ds_read_b64_tr_b16 v[90:91], v20 offset:35328
  s_waitcnt lgkmcnt(9)
  v_mfma_f32_32x32x16_bf16 v[24:39], v[64:67], v[68:71], v[24:39]
  ds_read_b128 v[100:103], v16 offset:27648
  ds_read_b64_tr_b16 v[96:97], v20 offset:36864
  ds_read_b64_tr_b16 v[98:99], v20 offset:37376
  s_barrier
  s_waitcnt lgkmcnt(9)
  v_mfma_f32_32x32x16_bf16 v[24:39], v[72:75], v[76:79], v[24:39]
  ds_read_b128 v[44:47], v16 offset:32768
  ds_read_b64_tr_b16 v[40:41], v20 offset:38912
  ds_read_b64_tr_b16 v[42:43], v20 offset:39424
  s_waitcnt lgkmcnt(9)
  v_mfma_f32_32x32x16_bf16 v[24:39], v[80:83], v[84:87], v[24:39]
  ds_read_b128 v[52:55], v16 offset:33792
  ds_read_b64_tr_b16 v[48:49], v20 offset:40960
  ds_read_b64_tr_b16 v[50:51], v20 offset:41472
  s_waitcnt lgkmcnt(9)
  v_mfma_f32_32x32x16_bf16 v[24:39], v[88:91], v[92:95], v[24:39]
  ds_read_b128 v[60:63], v16 offset:34816
  ds_read_b64_tr_b16 v[56:57], v20 offset:43008
  ds_read_b64_tr_b16 v[58:59], v20 offset:43520
  s_waitcnt lgkmcnt(9)
  v_mfma_f32_32x32x16_bf16 v[24:39], v[96:99], v[100:103], v[24:39]
  ds_read_b128 v[68:71], v16 offset:35840
  ds_read_b64_tr_b16 v[64:65], v20 offset:45056
  ds_read_b64_tr_b16 v[66:67], v20 offset:45568
  s_barrier
  s_waitcnt lgkmcnt(9)
  v_mfma_f32_32x32x16_bf16 v[24:39], v[40:43], v[44:47], v[24:39]
  ds_read_b128 v[76:79], v16 offset:40960
  ds_read_b64_tr_b16 v[72:73], v20 offset:47104
  ds_read_b64_tr_b16 v[74:75], v20 offset:47616
  s_waitcnt lgkmcnt(9)
  v_mfma_f32_32x32x16_bf16 v[24:39], v[48:51], v[52:55], v[24:39]
  ds_read_b128 v[84:87], v16 offset:41984
  ds_read_b64_tr_b16 v[80:81], v20 offset:49152
  ds_read_b64_tr_b16 v[82:83], v20 offset:49664
  s_waitcnt lgkmcnt(9)
  v_mfma_f32_32x32x16_bf16 v[24:39], v[56:59], v[60:63], v[24:39]
  ds_read_b128 v[92:95], v16 offset:43008
  ds_read_b64_tr_b16 v[88:89], v20 offset:51200
  ds_read_b64_tr_b16 v[90:91], v20 offset:51712
  s_waitcnt lgkmcnt(9)
  v_mfma_f32_32x32x16_bf16 v[24:39], v[64:67], v[68:71], v[24:39]
  ds_read_b128 v[100:103], v16 offset:44032
  ds_read_b64_tr_b16 v[96:97], v20 offset:53248
  ds_read_b64_tr_b16 v[98:99], v20 offset:53760
  s_barrier
  s_waitcnt lgkmcnt(9)
  v_mfma_f32_32x32x16_bf16 v[24:39], v[72:75], v[76:79], v[24:39]
  ds_read_b128 v[44:47], v16 offset:49152
  ds_read_b64_tr_b16 v[40:41], v20 offset:55296
  ds_read_b64_tr_b16 v[42:43], v20 offset:55808
  s_waitcnt lgkmcnt(9)
  v_mfma_f32_32x32x16_bf16 v[24:39], v[80:83], v[84:87], v[24:39]
  ds_read_b128 v[52:55], v16 offset:50176
  ds_read_b64_tr_b16 v[48:49], v20 offset:57344
  ds_read_b64_tr_b16 v[50:51], v20 offset:57856
  s_waitcnt lgkmcnt(9)
  v_mfma_f32_32x32x16_bf16 v[24:39], v[88:91], v[92:95], v[24:39]
  ds_read_b128 v[60:63], v16 offset:51200
  ds_read_b64_tr_b16 v[56:57], v20 offset:59392
  ds_read_b64_tr_b16 v[58:59], v20 offset:59904
  s_waitcnt lgkmcnt(9)
  v_mfma_f32_32x32x16_bf16 v[24:39], v[96:99], v[100:103], v[24:39]
  ds_read_b128 v[68:71], v16 offset:52224
  ds_read_b64_tr_b16 v[64:65], v20 offset:61440
  ds_read_b64_tr_b16 v[66:67], v20 offset:61952
  s_waitcnt lgkmcnt(9)
  v_mfma_f32_32x32x16_bf16 v[24:39], v[40:43], v[44:47], v[24:39]
  s_waitcnt lgkmcnt(6)
  v_mfma_f32_32x32x16_bf16 v[24:39], v[48:51], v[52:55], v[24:39]
  s_waitcnt lgkmcnt(3)
  v_mfma_f32_32x32x16_bf16 v[24:39], v[56:59], v[60:63], v[24:39]
  s_waitcnt lgkmcnt(0)
  v_mfma_f32_32x32x16_bf16 v[24:39], v[64:67], v[68:71], v[24:39]
  s_barrier
  s_nop 15
  v_cvt_pk_bf16_f32 v104, v24, v25
  v_cvt_pk_bf16_f32 v105, v26, v27
  v_cvt_pk_bf16_f32 v106, v28, v29
  v_cvt_pk_bf16_f32 v107, v30, v31
  v_cvt_pk_bf16_f32 v108, v32, v33
  v_cvt_pk_bf16_f32 v109, v34, v35
  v_cvt_pk_bf16_f32 v110, v36, v37
  v_cvt_pk_bf16_f32 v111, v38, v39
  s_nop 1
  v_permlane32_swap_b32 v104, v106
  v_permlane32_swap_b32 v105, v107
  v_permlane32_swap_b32 v108, v110
  v_permlane32_swap_b32 v109, v111
  buffer_store_dwordx4 v[104:107], v5, s[24:27], s63 offen offset:0 sc1
  buffer_store_dwordx4 v[108:111], v5, s[24:27], s63 offen offset:1024 sc1
  v_mov_b32 v114, 0
  v_mov_b32 v115, 0
  v_mov_b32 v116, 0x3f803f80
  v_dot2c_f32_bf16 v114, v104, v116
  v_dot2c_f32_bf16 v115, v104, v104
  v_dot2c_f32_bf16 v114, v105, v116
  v_dot2c_f32_bf16 v115, v105, v105
  v_dot2c_f32_bf16 v114, v106, v116
  v_dot2c_f32_bf16 v115, v106, v106
  v_dot2c_f32_bf16 v114, v107, v116
  v_dot2c_f32_bf16 v115, v107, v107
  v_dot2c_f32_bf16 v114, v108, v116
  v_dot2c_f32_bf16 v115, v108, v108
  v_dot2c_f32_bf16 v114, v109, v116
  v_dot2c_f32_bf16 v115, v109, v109
  v_dot2c_f32_bf16 v114, v110, v116
  v_dot2c_f32_bf16 v115, v110, v110
  v_dot2c_f32_bf16 v114, v111, v116
  v_dot2c_f32_bf16 v115, v111, v111
  s_nop 2
  v_mov_b32 v112, v114
  v_mov_b32 v113, v115
  s_nop 1
  v_permlane32_swap_b32 v112, v114
  v_permlane32_swap_b32 v113, v115
  s_lshr_b32 s56, s65, 5
  s_mul_i32 s56, s56, 3584
  s_lshl_b32 s57, s60, 9
  v_add_f32 v114, v114, v112
  v_add_f32 v115, v115, v113
  s_add_u32 s56, s56, s57
  s_lshl_b32 s57, s61, 8
  s_add_u32 s56, s56, s57
  s_add_u32 s56, s56, 0xc00000
  v_lshlrev_b32 v2, 3, v7
  buffer_store_dwordx2 v[114:115], v2, s[24:27], s56 offen sc1
  s_lshr_b32 s56, s59, 1
  s_lshl_b32 s12, s56, 7
  s_and_b32 s56, s59, 1
  s_mul_i32 s56, s56, 7
  s_add_u32 s56, s56, s60
  s_lshl_b32 s56, s56, 2
  s_add_u32 s12, s12, s56
  s_add_u32 s12, s12, 0xd81000
  s_waitcnt vmcnt(0)
  s_barrier
  s_cmp_lg_u32 s52, 0
  s_cbranch_scc1 Lpub_16
  s_add_u32 s56, s12, 0x8000
  buffer_store_dword v140, v141, s[24:27], s56 offen
  buffer_store_dword v140, v141, s[24:27], s12 offen sc0 sc1
Lpub_16:
  s_mul_i32 s56, s54, 4682
  s_lshr_b32 s56, s56, 16
  s_mul_i32 s57, s56, 14
  s_sub_u32 s67, s54, s57
  s_lshl_b32 s66, s53, 1
  s_add_u32 s66, s66, s56
  s_lshl_b32 s68, s66, 2
  s_add_u32 s68, s68, s52
  v_lshlrev_b32 v2, 4, v1
  s_mul_i32 s71, s68, 28672
  s_add_u32 s71, s71, 0x200000
  v_lshrrev_b32 v6, 5, v1
  v_and_b32 v7, 31, v1
  v_lshlrev_b32 v3, 3, v7
  v_mul_u32_u24 v4, 1792, v6
  v_add_u32 v3, v3, v4
  s_mul_i32 s72, s68, 3584
  s_add_u32 s72, s72, 0xc00000
  v_and_b32 v4, 15, v1
  v_lshrrev_b32 v4, 2, v4
  v_lshlrev_b32 v5, 3, v6
  v_add_u32 v5, v5, v4
  v_lshlrev_b32 v8, 7, v5
  v_bfe_u32 v5, v1, 4, 1
  v_lshlrev_b32 v20, 11, v5
  v_add_u32 v8, v8, v20
  v_lshlrev_b32 v5, 1, v5
  v_lshrrev_b32 v4, 1, v4
  v_or_b32 v5, v5, v4
  v_lshlrev_b32 v5, 5, v5
  v_add_u32 v8, v8, v5
  v_and_b32 v4, 3, v1
  v_lshlrev_b32 v4, 3, v4
  v_add_u32 v8, v8, v4
  v_xor_b32 v9, 32, v8
  v_xor_b32 v10, 64, v8
  v_xor_b32 v11, 96, v8
  v_add_u32 v12, 0x10000, v8
  v_add_u32 v13, 0x10000, v9
  v_add_u32 v14, 0x10000, v10
  v_add_u32 v15, 0x10000, v11
  v_add_u32 v16, 0x20000, v8
  v_add_u32 v17, 0x20000, v9
  v_add_u32 v18, 0x20000, v10
  v_add_u32 v19, 0x20000, v11
  v_lshlrev_b32 v20, 4, v6
  v_add_u32 v20, 162816, v20
  s_mul_i32 s69, s68, 112
  s_lshl_b32 s56, s67, 3
  s_add_u32 s69, s69, s56
  s_lshl_b32 s69, s69, 10
  s_add_u32 s69, s69, 0x400000
  s_add_u32 s70, s69, 4096
  s_lshl_b32 s13, s66, 7
  s_add_u32 s13, s13, 0xd81000
  v_and_b32 v142, 31, v1
  v_min_u32 v142, 13, v142
  v_lshlrev_b32 v142, 2, v142
  s_mov_b32 s58, 0
  s_mov_b32 s16, 0
Lpoll_17:
  s_and_b32 s17, s58, 3
  s_cmp_eq_u32 s17, 3
  s_cselect_b32 s17, 0, 0x8000
  s_add_u32 s17, s17, s13
  buffer_load_dword v143, v142, s[24:27], s17 offen sc1
  s_add_u32 s58, s58, 1
  s_cmp_gt_u32 s58, 0x80000
  s_cbranch_scc1 Lpoll_out_18
  s_waitcnt vmcnt(0)
  v_cmp_eq_u32 vcc, v143, v140
  s_nop 1
  s_or_b32 s16, s16, vcc_lo
  s_cmp_lg_u32 s16, -1
  s_cbranch_scc1 Lpoll_17
Lpoll_out_18:
  s_lshl_b32 s12, s66, 7
  s_lshl_b32 s56, s67, 2
  s_add_u32 s12, s12, s56
  s_add_u32 s14, s12, 0xd82000
  s_add_u32 s12, s12, 0xd81800
  s_add_u32 s56, s71, 0
  buffer_load_dwordx4 a[0:3], v2, s[24:27], s56 offen offset:0 sc1
  s_add_u32 s56, s71, 0
  buffer_load_dwordx4 a[4:7], v2, s[24:27], s56 offen offset:1024 sc1
  s_add_u32 s56, s71, 0
  buffer_load_dwordx4 a[8:11], v2, s[24:27], s56 offen offset:2048 sc1
  s_add_u32 s56, s71, 0
  buffer_load_dwordx4 a[12:15], v2, s[24:27], s56 offen offset:3072 sc1
  s_add_u32 s56, s71, 4096
  buffer_load_dwordx4 a[16:19], v2, s[24:27], s56 offen offset:0 sc1
  s_add_u32 s56, s71, 4096
  buffer_load_dwordx4 a[20:23], v2, s[24:27], s56 offen offset:1024 sc1
  s_add_u32 s56, s71, 4096
  buffer_load_dwordx4 a[24:27], v2, s[24:27], s56 offen offset:2048 sc1
  s_add_u32 s56, s71, 4096
  buffer_load_dwordx4 a[28:31], v2, s[24:27], s56 offen offset:3072 sc1
  s_barrier
  ds_read_b64_tr_b16 v[52:53], v8 offset:57344
  ds_read_b64_tr_b16 v[54:55], v8 offset:57856
  ds_read_b64_tr_b16 v[56:57], v9 offset:57344
  ds_read_b64_tr_b16 v[58:59], v9 offset:57856
  ds_read_b64_tr_b16 v[60:61], v8 offset:61440
  ds_read_b64_tr_b16 v[62:63], v8 offset:61952
  ds_read_b64_tr_b16 v[64:65], v9 offset:61440
  ds_read_b64_tr_b16 v[66:67], v9 offset:61952
  ds_read_b64_tr_b16 v[68:69], v12 offset:0
  ds_read_b64_tr_b16 v[70:71], v12 offset:512
  s_waitcnt vmcnt(7)
  s_waitcnt lgkmcnt(6)
  v_mfma_f32_32x32x16_bf16 v[76:91], v[52:55], a[0:3], 0
  ds_read_b64_tr_b16 v[72:73], v13 offset:0
  ds_read_b64_tr_b16 v[74:75], v13 offset:512
  v_mfma_f32_32x32x16_bf16 v[92:107], v[56:59], a[0:3], 0
  s_add_u32 s56, s71, 8192
  buffer_load_dwordx4 a[32:35], v2, s[24:27], s56 offen offset:0 sc1
  ds_read_b64_tr_b16 v[52:53], v16 offset:0
  ds_read_b64_tr_b16 v[54:55], v16 offset:512
  s_waitcnt vmcnt(7)
  s_waitcnt lgkmcnt(6)
  v_mfma_f32_32x32x16_bf16 v[76:91], v[60:63], a[4:7], v[76:91]
  ds_read_b64_tr_b16 v[56:57], v17 offset:0
  ds_read_b64_tr_b16 v[58:59], v17 offset:512
  v_mfma_f32_32x32x16_bf16 v[92:107], v[64:67], a[4:7], v[92:107]
  s_add_u32 s56, s71, 8192
  buffer_load_dwordx4 a[36:39], v2, s[24:27], s56 offen offset:1024 sc1
  ds_read_b64_tr_b16 v[60:61], v16 offset:4096
  ds_read_b64_tr_b16 v[62:63], v16 offset:4608
  s_waitcnt vmcnt(7)
  s_waitcnt lgkmcnt(6)
  v_mfma_f32_32x32x16_bf16 v[76:91], v[68:71], a[8:11], v[76:91]
  ds_read_b64_tr_b16 v[64:65], v17 offset:4096
  ds_read_b64_tr_b16 v[66:67], v17 offset:4608
  v_mfma_f32_32x32x16_bf16 v[92:107], v[72:75], a[8:11], v[92:107]
  s_add_u32 s56, s71, 8192
  buffer_load_dwordx4 a[40:43], v2, s[24:27], s56 offen offset:2048 sc1
  ds_read_b64_tr_b16 v[68:69], v16 offset:8192
  ds_read_b64_tr_b16 v[70:71], v16 offset:8704
  s_waitcnt vmcnt(7)
  s_waitcnt lgkmcnt(6)
  v_mfma_f32_32x32x16_bf16 v[76:91], v[52:55], a[12:15], v[76:91]
  buffer_load_dwordx2 v[108:109], v3, s[24:27], s72 offen offset:0 sc1
  ds_read_b64_tr_b16 v[72:73], v17 offset:8192
  ds_read_b64_tr_b16 v[74:75], v17 offset:8704
  v_mfma_f32_32x32x16_bf16 v[92:107], v[56:59], a[12:15], v[92:107]
  s_add_u32 s56, s71, 8192
  buffer_load_dwordx4 a[44:47], v2, s[24:27], s56 offen offset:3072 sc1
  ds_read_b64_tr_b16 v[52:53], v16 offset:12288
  ds_read_b64_tr_b16 v[54:55], v16 offset:12800
  s_waitcnt vmcnt(8)
  s_waitcnt lgkmcnt(6)
  v_mfma_f32_32x32x16_bf16 v[76:91], v[60:63], a[16:19], v[76:91]
  buffer_load_dwordx2 v[110:111], v3, s[24:27], s72 offen offset:256 sc1
  ds_read_b64_tr_b16 v[56:57], v17 offset:12288
  ds_read_b64_tr_b16 v[58:59], v17 offset:12800
  v_mfma_f32_32x32x16_bf16 v[92:107], v[64:67], a[16:19], v[92:107]
  s_add_u32 s56, s71, 12288
  buffer_load_dwordx4 a[48:51], v2, s[24:27], s56 offen offset:0 sc1
  ds_read_b64_tr_b16 v[60:61], v16 offset:16384
  ds_read_b64_tr_b16 v[62:63], v16 offset:16896
  s_waitcnt vmcnt(9)
  s_waitcnt lgkmcnt(6)
  v_mfma_f32_32x32x16_bf16 v[76:91], v[68:71], a[20:23], v[76:91]
  buffer_load_dwordx2 v[112:113], v3, s[24:27], s72 offen offset:512 sc1
  ds_read_b64_tr_b16 v[64:65], v17 offset:16384
  ds_read_b64_tr_b16 v[66:67], v17 offset:16896
  v_mfma_f32_32x32x16_bf16 v[92:107], v[72:75], a[20:23], v[92:107]
  s_add_u32 s56, s71, 12288
  buffer_load_dwordx4 a[52:55], v2, s[24:27], s56 offen offset:1024 sc1
  ds_read_b64_tr_b16 v[68:69], v16 offset:20480
  ds_read_b64_tr_b16 v[70:71], v16 offset:20992
  s_waitcnt vmcnt(10)
  s_waitcnt lgkmcnt(6)
  v_mfma_f32_32x32x16_bf16 v[76:91], v[52:55], a[24:27], v[76:91]
  buffer_load_dwordx2 v[114:115], v3, s[24:27], s72 offen offset:768 sc1
  ds_read_b64_tr_b16 v[72:73], v17 offset:20480
  ds_read_b64_tr_b16 v[74:75], v17 offset:20992
  v_mfma_f32_32x32x16_bf16 v[92:107], v[56:59], a[24:27], v[92:107]
  s_add_u32 s56, s71, 12288
  buffer_load_dwordx4 a[56:59], v2, s[24:27], s56 offen offset:2048 sc1
  ds_read_b64_tr_b16 v[52:53], v16 offset:24576
  ds_read_b64_tr_b16 v[54:55], v16 offset:25088
  s_waitcnt vmcnt(11)
  s_waitcnt lgkmcnt(6)
  v_mfma_f32_32x32x16_bf16 v[76:91], v[60:63], a[28:31], v[76:91]
  buffer_load_dwordx2 v[116:117], v3, s[24:27], s72 offen offset:1024 sc1
  ds_read_b64_tr_b16 v[56:57], v17 offset:24576
  ds_read_b64_tr_b16 v[58:59], v17 offset:25088
  v_mfma_f32_32x32x16_bf16 v[92:107], v[64:67], a[28:31], v[92:107]
  s_add_u32 s56, s71, 12288
  buffer_load_dwordx4 a[60:63], v2, s[24:27], s56 offen offset:3072 sc1
  ds_read_b64_tr_b16 v[60:61], v12 offset:4096
  ds_read_b64_tr_b16 v[62:63], v12 offset:4608
  s_barrier
  s_waitcnt vmcnt(12)
  s_waitcnt lgkmcnt(6)
  v_mfma_f32_32x32x16_bf16 v[76:91], v[68:71], a[32:35], v[76:91]
  buffer_load_dwordx2 v[118:119], v3, s[24:27], s72 offen offset:1280 sc1
  ds_read_b64_tr_b16 v[64:65], v13 offset:4096
  ds_read_b64_tr_b16 v[66:67], v13 offset:4608
  v_mfma_f32_32x32x16_bf16 v[92:107], v[72:75], a[32:35], v[92:107]
  s_add_u32 s56, s71, 16384
  buffer_load_dwordx4 a[64:67], v2, s[24:27], s56 offen offset:0 sc1
  ds_read_b64_tr_b16 v[68:69], v12 offset:8192
  ds_read_b64_tr_b16 v[70:71], v12 offset:8704
  s_waitcnt vmcnt(13)
  s_waitcnt lgkmcnt(6)
  v_mfma_f32_32x32x16_bf16 v[76:91], v[52:55], a[36:39], v[76:91]
  buffer_load_dwordx2 v[120:121], v3, s[24:27], s72 offen offset:1536 sc1
  ds_read_b64_tr_b16 v[72:73], v13 offset:8192
  ds_read_b64_tr_b16 v[74:75], v13 offset:8704
  v_mfma_f32_32x32x16_bf16 v[92:107], v[56:59], a[36:39], v[92:107]
  s_add_u32 s56, s71, 16384
  buffer_load_dwordx4 a[68:71], v2, s[24:27], s56 offen offset:1024 sc1
  ds_read_b64_tr_b16 v[52:53], v12 offset:12288
  ds_read_b64_tr_b16 v[54:55], v12 offset:12800
  s_waitcnt vmcnt(14)
  s_waitcnt lgkmcnt(6)
  v_mfma_f32_32x32x16_bf16 v[76:91], v[60:63], a[40:43], v[76:91]
  ds_read_b64_tr_b16 v[56:57], v13 offset:12288
  ds_read_b64_tr_b16 v[58:59], v13 offset:12800
  v_mfma_f32_32x32x16_bf16 v[92:107], v[64:67], a[40:43], v[92:107]
  s_add_u32 s56, s71, 16384
  buffer_load_dwordx4 a[72:75], v2, s[24:27], s56 offen offset:2048 sc1
  ds_read_b64_tr_b16 v[60:61], v12 offset:16384
  ds_read_b64_tr_b16 v[62:63], v12 offset:16896
  s_waitcnt vmcnt(13)
  s_waitcnt lgkmcnt(6)
  v_mfma_f32_32x32x16_bf16 v[76:91], v[68:71], a[44:47], v[76:91]
  ds_read_b64_tr_b16 v[64:65], v13 offset:16384
  ds_read_b64_tr_b16 v[66:67], v13 offset:16896
  v_mfma_f32_32x32x16_bf16 v[92:107], v[72:75], a[44:47], v[92:107]
  s_add_u32 s56, s71, 16384
  buffer_load_dwordx4 a[76:79], v2, s[24:27], s56 offen offset:3072 sc1
  ds_read_b64_tr_b16 v[68:69], v12 offset:20480
  ds_read_b64_tr_b16 v[70:71], v12 offset:20992
  s_waitcnt vmcnt(12)
  s_waitcnt lgkmcnt(6)
  v_mfma_f32_32x32x16_bf16 v[76:91], v[52:55], a[48:51], v[76:91]
  ds_read_b64_tr_b16 v[72:73], v13 offset:20480
  ds_read_b64_tr_b16 v[74:75], v13 offset:20992
  v_mfma_f32_32x32x16_bf16 v[92:107], v[56:59], a[48:51], v[92:107]
  s_add_u32 s56, s71, 20480
  buffer_load_dwordx4 a[80:83], v2, s[24:27], s56 offen offset:0 sc1
  ds_read_b64_tr_b16 v[52:53], v12 offset:24576
  ds_read_b64_tr_b16 v[54:55], v12 offset:25088
  s_waitcnt vmcnt(11)
  s_waitcnt lgkmcnt(6)
  v_mfma_f32_32x32x16_bf16 v[76:91], v[60:63], a[52:55], v[76:91]
  ds_read_b64_tr_b16 v[56:57], v13 offset:24576
  ds_read_b64_tr_b16 v[58:59], v13 offset:25088
  v_mfma_f32_32x32x16_bf16 v[92:107], v[64:67], a[52:55], v[92:107]
  s_add_u32 s56, s71, 20480
  buffer_load_dwordx4 a[84:87], v2, s[24:27], s56 offen offset:1024 sc1
  ds_read_b64_tr_b16 v[60:61], v12 offset:28672
  ds_read_b64_tr_b16 v[62:63], v12 offset:29184
  s_waitcnt vmcnt(10)
  s_waitcnt lgkmcnt(6)
  v_mfma_f32_32x32x16_bf16 v[76:91], v[68:71], a[56:59], v[76:91]
  ds_read_b64_tr_b16 v[64:65], v13 offset:28672
  ds_read_b64_tr_b16 v[66:67], v13 offset:29184
  v_mfma_f32_32x32x16_bf16 v[92:107], v[72:75], a[56:59], v[92:107]
  s_add_u32 s56, s71, 20480
  buffer_load_dwordx4 a[88:91], v2, s[24:27], s56 offen offset:2048 sc1
  ds_read_b64_tr_b16 v[68:69], v8 offset:0
  ds_read_b64_tr_b16 v[70:71], v8 offset:512
  s_waitcnt vmcnt(9)
  s_waitcnt lgkmcnt(6)
  v_mfma_f32_32x32x16_bf16 v[76:91], v[52:55], a[60:63], v[76:91]
  ds_read_b64_tr_b16 v[72:73], v9 offset:0
  ds_read_b64_tr_b16 v[74:75], v9 offset:512
  v_mfma_f32_32x32x16_bf16 v[92:107], v[56:59], a[60:63], v[92:107]
  s_add_u32 s56, s71, 20480
  buffer_load_dwordx4 a[92:95], v2, s[24:27], s56 offen offset:3072 sc1
  ds_read_b64_tr_b16 v[52:53], v8 offset:4096
  ds_read_b64_tr_b16 v[54:55], v8 offset:4608
  s_barrier
  s_waitcnt vmcnt(8)
  s_waitcnt lgkmcnt(6)
  v_mfma_f32_32x32x16_bf16 v[76:91], v[60:63], a[64:67], v[76:91]
  ds_read_b64_tr_b16 v[56:57], v9 offset:4096
  ds_read_b64_tr_b16 v[58:59], v9 offset:4608
  v_mfma_f32_32x32x16_bf16 v[92:107], v[64:67], a[64:67], v[92:107]
  s_add_u32 s56, s71, 24576
  buffer_load_dwordx4 a[96:99], v2, s[24:27], s56 offen offset:0 sc1
  ds_read_b64_tr_b16 v[60:61], v8 offset:8192
  ds_read_b64_tr_b16 v[62:63], v8 offset:8704
  s_waitcnt vmcnt(7)
  s_waitcnt lgkmcnt(6)
  v_mfma_f32_32x32x16_bf16 v[76:91], v[68:71], a[68:71], v[76:91]
  ds_read_b64_tr_b16 v[64:65], v9 offset:8192
  ds_read_b64_tr_b16 v[66:67], v9 offset:8704
  v_mfma_f32_32x32x16_bf16 v[92:107], v[72:75], a[68:71], v[92:107]
  s_add_u32 s56, s71, 24576
  buffer_load_dwordx4 a[100:103], v2, s[24:27], s56 offen offset:1024 sc1
  ds_read_b64_tr_b16 v[68:69], v8 offset:12288
  ds_read_b64_tr_b16 v[70:71], v8 offset:12800
  s_waitcnt vmcnt(7)
  s_waitcnt lgkmcnt(6)
  v_mfma_f32_32x32x16_bf16 v[76:91], v[52:55], a[72:75], v[76:91]
  ds_read_b64_tr_b16 v[72:73], v9 offset:12288
  ds_read_b64_tr_b16 v[74:75], v9 offset:12800
  v_mfma_f32_32x32x16_bf16 v[92:107], v[56:59], a[72:75], v[92:107]
  s_add_u32 s56, s71, 24576
  buffer_load_dwordx4 a[104:107], v2, s[24:27], s56 offen offset:2048 sc1
  ds_read_b64_tr_b16 v[52:53], v8 offset:16384
  ds_read_b64_tr_b16 v[54:55], v8 offset:16896
  s_waitcnt vmcnt(7)
  s_waitcnt lgkmcnt(6)
  v_mfma_f32_32x32x16_bf16 v[76:91], v[60:63], a[76:79], v[76:91]
  ds_read_b64_tr_b16 v[56:57], v9 offset:16384
  ds_read_b64_tr_b16 v[58:59], v9 offset:16896
  v_mfma_f32_32x32x16_bf16 v[92:107], v[64:67], a[76:79], v[92:107]
  s_add_u32 s56, s71, 24576
  buffer_load_dwordx4 a[108:111], v2, s[24:27], s56 offen offset:3072 sc1
  ds_read_b64_tr_b16 v[60:61], v8 offset:20480
  ds_read_b64_tr_b16 v[62:63], v8 offset:20992
  s_waitcnt vmcnt(7)
  s_waitcnt lgkmcnt(6)
  v_mfma_f32_32x32x16_bf16 v[76:91], v[68:71], a[80:83], v[76:91]
  ds_read_b64_tr_b16 v[64:65], v9 offset:20480
  ds_read_b64_tr_b16 v[66:67], v9 offset:20992
  v_add_f32 v108, v108, v110
  v_add_f32 v109, v109, v111
  v_mfma_f32_32x32x16_bf16 v[92:107], v[72:75], a[80:83], v[92:107]
  ds_read_b64_tr_b16 v[68:69], v8 offset:24576
  ds_read_b64_tr_b16 v[70:71], v8 offset:25088
  v_add_f32 v108, v108, v112
  v_add_f32 v109, v109, v113
  v_add_f32 v108, v108, v114
  s_waitcnt vmcnt(6)
  s_waitcnt lgkmcnt(6)
  v_mfma_f32_32x32x16_bf16 v[76:91], v[52:55], a[84:87], v[76:91]
  ds_read_b64_tr_b16 v[72:73], v9 offset:24576
  ds_read_b64_tr_b16 v[74:75], v9 offset:25088
  v_add_f32 v109, v109, v115
  v_add_f32 v108, v108, v116
  v_add_f32 v109, v109, v117
  v_mfma_f32_32x32x16_bf16 v[92:107], v[56:59], a[84:87], v[92:107]
  ds_read_b64_tr_b16 v[52:53], v8 offset:28672
  ds_read_b64_tr_b16 v[54:55], v8 offset:29184
  v_add_f32 v108, v108, v118
  v_add_f32 v109, v109, v119
  v_add_f32 v108, v108, v120
  s_waitcnt vmcnt(5)
  s_waitcnt lgkmcnt(6)
  v_mfma_f32_32x32x16_bf16 v[76:91], v[60:63], a[88:91], v[76:91]
  ds_read_b64_tr_b16 v[56:57], v9 offset:28672
  ds_read_b64_tr_b16 v[58:59], v9 offset:29184
  v_add_f32 v109, v109, v121
  v_mov_b32 v110, v108
  v_mov_b32 v111, v109
  s_nop 1
  v_permlane32_swap_b32 v110, v108
  v_permlane32_swap_b32 v111, v109
  s_nop 1
  v_mfma_f32_32x32x16_bf16 v[92:107], v[64:67], a[88:91], v[92:107]
  ds_read_b64_tr_b16 v[60:61], v8 offset:32768
  ds_read_b64_tr_b16 v[62:63], v8 offset:33280
  v_add_f32 v108, v108, v110
  v_add_f32 v109, v109, v111
  v_mul_f32 v21, 0xbb124925, v108
  v_mul_f32 v109, 0x3b124925, v109
  s_waitcnt vmcnt(4)
  s_waitcnt lgkmcnt(6)
  v_mfma_f32_32x32x16_bf16 v[76:91], v[68:71], a[92:95], v[76:91]
  ds_read_b64_tr_b16 v[64:65], v9 offset:32768
  ds_read_b64_tr_b16 v[66:67], v9 offset:33280
  v_fma_f32 v23, -v21, v21, v109
  v_max_f32 v23, 0, v23
  v_add_f32 v23, 0x3727c5ac, v23
  v_mfma_f32_32x32x16_bf16 v[92:107], v[72:75], a[92:95], v[92:107]
  ds_read_b64_tr_b16 v[68:69], v8 offset:36864
  ds_read_b64_tr_b16 v[70:71], v8 offset:37376
  v_rsq_f32 v22, v23
  s_nop 0
  v_mul_f32 v22, 0xbfb8aa3b, v22
  s_barrier
  s_waitcnt vmcnt(3)
  s_waitcnt lgkmcnt(6)
  v_mfma_f32_32x32x16_bf16 v[76:91], v[52:55], a[96:99], v[76:91]
  ds_read_b64_tr_b16 v[72:73], v9 offset:36864
  ds_read_b64_tr_b16 v[74:75], v9 offset:37376
  v_mfma_f32_32x32x16_bf16 v[92:107], v[56:59], a[96:99], v[92:107]
  ds_read_b64_tr_b16 v[52:53], v8 offset:40960
  ds_read_b64_tr_b16 v[54:55], v8 offset:41472
  s_waitcnt vmcnt(2)
  s_waitcnt lgkmcnt(6)
  v_mfma_f32_32x32x16_bf16 v[76:91], v[60:63], a[100:103], v[76:91]
  ds_read_b64_tr_b16 v[56:57], v9 offset:40960
  ds_read_b64_tr_b16 v[58:59], v9 offset:41472
  v_mfma_f32_32x32x16_bf16 v[92:107], v[64:67], a[100:103], v[92:107]
  ds_read_b64_tr_b16 v[60:61], v10 offset:57344
  ds_read_b64_tr_b16 v[62:63], v10 offset:57856
  s_waitcnt vmcnt(1)
  s_waitcnt lgkmcnt(6)
  v_mfma_f32_32x32x16_bf16 v[76:91], v[68:71], a[104:107], v[76:91]
  ds_read_b64_tr_b16 v[64:65], v11 offset:57344
  ds_read_b64_tr_b16 v[66:67], v11 offset:57856
  v_mfma_f32_32x32x16_bf16 v[92:107], v[72:75], a[104:107], v[92:107]
  ds_read_b64_tr_b16 v[68:69], v10 offset:61440
  ds_read_b64_tr_b16 v[70:71], v10 offset:61952
  s_waitcnt vmcnt(0)
  s_waitcnt lgkmcnt(6)
  v_mfma_f32_32x32x16_bf16 v[76:91], v[52:55], a[108:111], v[76:91]
  ds_read_b64_tr_b16 v[72:73], v11 offset:61440
  ds_read_b64_tr_b16 v[74:75], v11 offset:61952
  v_mfma_f32_32x32x16_bf16 v[92:107], v[56:59], a[108:111], v[92:107]
  ds_read_b64_tr_b16 v[52:53], v14 offset:0
  ds_read_b64_tr_b16 v[54:55], v14 offset:512
  s_waitcnt lgkmcnt(6)
  v_mfma_f32_32x32x16_bf16 v[108:123], v[60:63], a[0:3], 0
  ds_read_b64_tr_b16 v[56:57], v15 offset:0
  ds_read_b64_tr_b16 v[58:59], v15 offset:512
  v_mfma_f32_32x32x16_bf16 v[124:139], v[64:67], a[0:3], 0
  ds_read_b64_tr_b16 v[60:61], v18 offset:0
  ds_read_b64_tr_b16 v[62:63], v18 offset:512
  s_waitcnt lgkmcnt(6)
  v_mfma_f32_32x32x16_bf16 v[108:123], v[68:71], a[4:7], v[108:123]
  ds_read_b64_tr_b16 v[64:65], v19 offset:0
  ds_read_b64_tr_b16 v[66:67], v19 offset:512
  v_mfma_f32_32x32x16_bf16 v[124:139], v[72:75], a[4:7], v[124:139]
  ds_read_b64_tr_b16 v[68:69], v18 offset:4096
  ds_read_b64_tr_b16 v[70:71], v18 offset:4608
  s_waitcnt lgkmcnt(6)
  v_mfma_f32_32x32x16_bf16 v[108:123], v[52:55], a[8:11], v[108:123]
  ds_read_b64_tr_b16 v[72:73], v19 offset:4096
  ds_read_b64_tr_b16 v[74:75], v19 offset:4608
  v_mfma_f32_32x32x16_bf16 v[124:139], v[56:59], a[8:11], v[124:139]
  ds_read_b64_tr_b16 v[52:53], v18 offset:8192
  ds_read_b64_tr_b16 v[54:55], v18 offset:8704
  s_waitcnt lgkmcnt(6)
  v_mfma_f32_32x32x16_bf16 v[108:123], v[60:63], a[12:15], v[108:123]
  ds_read_b64_tr_b16 v[56:57], v19 offset:8192
  ds_read_b64_tr_b16 v[58:59], v19 offset:8704
  v_mfma_f32_32x32x16_bf16 v[124:139], v[64:67], a[12:15], v[124:139]
  ds_read_b64_tr_b16 v[60:61], v18 offset:12288
  ds_read_b64_tr_b16 v[62:63], v18 offset:12800
  s_barrier
  s_waitcnt lgkmcnt(6)
  v_mfma_f32_32x32x16_bf16 v[108:123], v[68:71], a[16:19], v[108:123]
  ds_read_b64_tr_b16 v[64:65], v19 offset:12288
  ds_read_b64_tr_b16 v[66:67], v19 offset:12800
  ds_read_b128 v[36:39], v20 offset:0
  ds_read_b128 v[40:43], v20 offset:32
  ds_read_b128 v[44:47], v20 offset:512
  ds_read_b128 v[48:51], v20 offset:544
  v_mfma_f32_32x32x16_bf16 v[124:139], v[72:75], a[16:19], v[124:139]
  ds_read_b64_tr_b16 v[68:69], v18 offset:16384
  ds_read_b64_tr_b16 v[70:71], v18 offset:16896
  s_waitcnt lgkmcnt(2)
  v_fmac_f32 v76, v21, v36
  v_fmac_f32 v77, v21, v37
  v_fmac_f32 v78, v21, v38
  v_mfma_f32_32x32x16_bf16 v[108:123], v[52:55], a[20:23], v[108:123]
  ds_read_b64_tr_b16 v[72:73], v19 offset:16384
  ds_read_b64_tr_b16 v[74:75], v19 offset:16896
  v_fmac_f32 v79, v21, v39
  v_fmac_f32 v80, v21, v40
  v_fmac_f32 v81, v21, v41
  v_fmac_f32 v82, v21, v42
  v_mfma_f32_32x32x16_bf16 v[124:139], v[56:59], a[20:23], v[124:139]
  ds_read_b64_tr_b16 v[52:53], v18 offset:20480
  ds_read_b64_tr_b16 v[54:55], v18 offset:20992
  v_fmac_f32 v83, v21, v43
  v_fmac_f32 v84, v21, v44
  v_fmac_f32 v85, v21, v45
  v_fmac_f32 v86, v21, v46
  v_mfma_f32_32x32x16_bf16 v[108:123], v[60:63], a[24:27], v[108:123]
  ds_read_b64_tr_b16 v[56:57], v19 offset:20480
  ds_read_b64_tr_b16 v[58:59], v19 offset:20992
  v_fmac_f32 v87, v21, v47
  v_fmac_f32 v88, v21, v48
  v_fmac_f32 v89, v21, v49
  v_fmac_f32 v90, v21, v50
  v_mfma_f32_32x32x16_bf16 v[124:139], v[64:67], a[24:27], v[124:139]
  ds_read_b64_tr_b16 v[60:61], v18 offset:24576
  ds_read_b64_tr_b16 v[62:63], v18 offset:25088
  v_fmac_f32 v91, v21, v51
  ds_read_b128 v[36:39], v20 offset:64
  ds_read_b128 v[40:43], v20 offset:96
  ds_read_b128 v[44:47], v20 offset:576
  s_waitcnt lgkmcnt(9)
  v_mfma_f32_32x32x16_bf16 v[108:123], v[68:71], a[28:31], v[108:123]
  ds_read_b64_tr_b16 v[64:65], v19 offset:24576
  ds_read_b64_tr_b16 v[66:67], v19 offset:25088
  ds_read_b128 v[48:51], v20 offset:608
  v_mul_f32 v24, v22, v76
  v_mul_f32 v25, v22, v77
  v_mul_f32 v26, v22, v78
  v_mfma_f32_32x32x16_bf16 v[124:139], v[72:75], a[28:31], v[124:139]
  ds_read_b64_tr_b16 v[68:69], v14 offset:4096
  ds_read_b64_tr_b16 v[70:71], v14 offset:4608
  v_mul_f32 v27, v22, v79
  v_mul_f32 v28, v22, v80
  v_mul_f32 v29, v22, v81
  v_mul_f32 v30, v22, v82
  s_waitcnt lgkmcnt(10)
  v_mfma_f32_32x32x16_bf16 v[108:123], v[52:55], a[32:35], v[108:123]
  ds_read_b64_tr_b16 v[72:73], v15 offset:4096
  ds_read_b64_tr_b16 v[74:75], v15 offset:4608
  v_mul_f32 v31, v22, v83
  v_exp_f32 v24, v24
  v_exp_f32 v25, v25
  v_exp_f32 v26, v26
  v_mfma_f32_32x32x16_bf16 v[124:139], v[56:59], a[32:35], v[124:139]
  ds_read_b64_tr_b16 v[52:53], v14 offset:8192
  ds_read_b64_tr_b16 v[54:55], v14 offset:8704
  v_exp_f32 v27, v27
  v_exp_f32 v28, v28
  v_exp_f32 v29, v29
  v_exp_f32 v30, v30
  s_waitcnt lgkmcnt(7)
  v_mfma_f32_32x32x16_bf16 v[108:123], v[60:63], a[36:39], v[108:123]
  ds_read_b64_tr_b16 v[56:57], v15 offset:8192
  ds_read_b64_tr_b16 v[58:59], v15 offset:8704
  v_exp_f32 v31, v31
  v_mul_f32 v76, v76, v84
  v_mul_f32 v77, v77, v85
  v_mul_f32 v78, v78, v86
  v_mfma_f32_32x32x16_bf16 v[124:139], v[64:67], a[36:39], v[124:139]
  ds_read_b64_tr_b16 v[60:61], v14 offset:12288
  ds_read_b64_tr_b16 v[62:63], v14 offset:12800
  v_mul_f32 v79, v79, v87
  v_mul_f32 v80, v80, v88
  v_mul_f32 v81, v81, v89
  v_mul_f32 v82, v82, v90
  s_waitcnt lgkmcnt(6)
  v_mfma_f32_32x32x16_bf16 v[108:123], v[68:71], a[40:43], v[108:123]
  ds_read_b64_tr_b16 v[64:65], v15 offset:12288
  ds_read_b64_tr_b16 v[66:67], v15 offset:12800
  v_mul_f32 v83, v83, v91
  v_fma_f32 v24, v24, v23, v23
  v_fma_f32 v25, v25, v23, v23
  v_fma_f32 v26, v26, v23, v23
  v_mfma_f32_32x32x16_bf16 v[124:139], v[72:75], a[40:43], v[124:139]
  ds_read_b64_tr_b16 v[68:69], v14 offset:16384
  ds_read_b64_tr_b16 v[70:71], v14 offset:16896
  v_fma_f32 v27, v27, v23, v23
  v_fma_f32 v28, v28, v23, v23
  v_fma_f32 v29, v29, v23, v23
  v_fma_f32 v30, v30, v23, v23
  s_waitcnt lgkmcnt(6)
  v_mfma_f32_32x32x16_bf16 v[108:123], v[52:55], a[44:47], v[108:123]
  ds_read_b64_tr_b16 v[72:73], v15 offset:16384
  ds_read_b64_tr_b16 v[74:75], v15 offset:16896
  v_fma_f32 v31, v31, v23, v23
  v_rcp_f32 v24, v24
  v_rcp_f32 v25, v25
  v_rcp_f32 v26, v26
  v_mfma_f32_32x32x16_bf16 v[124:139], v[56:59], a[44:47], v[124:139]
  ds_read_b64_tr_b16 v[52:53], v14 offset:20480
  ds_read_b64_tr_b16 v[54:55], v14 offset:20992
  v_rcp_f32 v27, v27
  v_rcp_f32 v28, v28
  v_rcp_f32 v29, v29
  v_rcp_f32 v30, v30
  s_barrier
  s_waitcnt lgkmcnt(6)
  v_mfma_f32_32x32x16_bf16 v[108:123], v[60:63], a[48:51], v[108:123]
  ds_read_b64_tr_b16 v[56:57], v15 offset:20480
  ds_read_b64_tr_b16 v[58:59], v15 offset:20992
  v_rcp_f32 v31, v31
  v_mul_f32 v76, v76, v24
  v_mul_f32 v77, v77, v25
  v_mul_f32 v78, v78, v26
  v_mfma_f32_32x32x16_bf16 v[124:139], v[64:67], a[48:51], v[124:139]
  ds_read_b64_tr_b16 v[60:61], v14 offset:24576
  ds_read_b64_tr_b16 v[62:63], v14 offset:25088
  v_mul_f32 v79, v79, v27
  v_mul_f32 v80, v80, v28
  v_mul_f32 v81, v81, v29
  v_mul_f32 v82, v82, v30
  s_waitcnt lgkmcnt(6)
  v_mfma_f32_32x32x16_bf16 v[108:123], v[68:71], a[52:55], v[108:123]
  ds_read_b64_tr_b16 v[64:65], v15 offset:24576
  ds_read_b64_tr_b16 v[66:67], v15 offset:25088
  v_mul_f32 v83, v83, v31
  v_cvt_pk_bf16_f32 v32, v76, v77
  v_cvt_pk_bf16_f32 v33, v78, v79
  v_cvt_pk_bf16_f32 v34, v80, v81
  v_mfma_f32_32x32x16_bf16 v[124:139], v[72:75], a[52:55], v[124:139]
  ds_read_b64_tr_b16 v[68:69], v14 offset:28672
  ds_read_b64_tr_b16 v[70:71], v14 offset:29184
  v_cvt_pk_bf16_f32 v35, v82, v83
  s_nop 1
  v_permlane32_swap_b32 v32, v34
  v_permlane32_swap_b32 v33, v35
  s_waitcnt lgkmcnt(6)
  v_mfma_f32_32x32x16_bf16 v[108:123], v[52:55], a[56:59], v[108:123]
  ds_read_b64_tr_b16 v[72:73], v15 offset:28672
  ds_read_b64_tr_b16 v[74:75], v15 offset:29184
  buffer_store_dwordx4 v[32:35], v2, s[24:27], s69 offen offset:0 sc1
  s_nop 1
  v_fmac_f32 v92, v21, v36
  v_mfma_f32_32x32x16_bf16 v[124:139], v[56:59], a[56:59], v[124:139]
  ds_read_b64_tr_b16 v[52:53], v10 offset:0
  ds_read_b64_tr_b16 v[54:55], v10 offset:512
  v_fmac_f32 v93, v21, v37
  v_fmac_f32 v94, v21, v38
  v_fmac_f32 v95, v21, v39
  v_fmac_f32 v96, v21, v40
  s_waitcnt lgkmcnt(6)
  v_mfma_f32_32x32x16_bf16 v[108:123], v[60:63], a[60:63], v[108:123]
  ds_read_b64_tr_b16 v[56:57], v11 offset:0
  ds_read_b64_tr_b16 v[58:59], v11 offset:512
  v_fmac_f32 v97, v21, v41
  v_fmac_f32 v98, v21, v42
  v_fmac_f32 v99, v21, v43
  v_fmac_f32 v100, v21, v44
  v_mfma_f32_32x32x16_bf16 v[124:139], v[64:67], a[60:63], v[124:139]
  ds_read_b64_tr_b16 v[60:61], v10 offset:4096
  ds_read_b64_tr_b16 v[62:63], v10 offset:4608
  v_fmac_f32 v101, v21, v45
  v_fmac_f32 v102, v21, v46
  v_fmac_f32 v103, v21, v47
  v_fmac_f32 v104, v21, v48
  s_waitcnt lgkmcnt(6)
  v_mfma_f32_32x32x16_bf16 v[108:123], v[68:71], a[64:67], v[108:123]
  ds_read_b64_tr_b16 v[64:65], v11 offset:4096
  ds_read_b64_tr_b16 v[66:67], v11 offset:4608
  v_fmac_f32 v105, v21, v49
  v_fmac_f32 v106, v21, v50
  v_fmac_f32 v107, v21, v51
  ds_read_b128 v[36:39], v20 offset:128
  v_mfma_f32_32x32x16_bf16 v[124:139], v[72:75], a[64:67], v[124:139]
  ds_read_b64_tr_b16 v[68:69], v10 offset:8192
  ds_read_b64_tr_b16 v[70:71], v10 offset:8704
  ds_read_b128 v[40:43], v20 offset:160
  ds_read_b128 v[44:47], v20 offset:640
  ds_read_b128 v[48:51], v20 offset:672
  v_mul_f32 v24, v22, v92
  s_waitcnt lgkmcnt(10)
  v_mfma_f32_32x32x16_bf16 v[108:123], v[52:55], a[68:71], v[108:123]
  ds_read_b64_tr_b16 v[72:73], v11 offset:8192
  ds_read_b64_tr_b16 v[74:75], v11 offset:8704
  v_mul_f32 v25, v22, v93
  v_mul_f32 v26, v22, v94
  v_mul_f32 v27, v22, v95
  v_mul_f32 v28, v22, v96
  v_mfma_f32_32x32x16_bf16 v[124:139], v[56:59], a[68:71], v[124:139]
  ds_read_b64_tr_b16 v[52:53], v10 offset:12288
  ds_read_b64_tr_b16 v[54:55], v10 offset:12800
  v_mul_f32 v29, v22, v97
  v_mul_f32 v30, v22, v98
  v_mul_f32 v31, v22, v99
  v_exp_f32 v24, v24
  s_waitcnt lgkmcnt(10)
  v_mfma_f32_32x32x16_bf16 v[108:123], v[60:63], a[72:75], v[108:123]
  ds_read_b64_tr_b16 v[56:57], v11 offset:12288
  ds_read_b64_tr_b16 v[58:59], v11 offset:12800
  v_exp_f32 v25, v25
  v_exp_f32 v26, v26
  v_exp_f32 v27, v27
  v_exp_f32 v28, v28
  v_mfma_f32_32x32x16_bf16 v[124:139], v[64:67], a[72:75], v[124:139]
  ds_read_b64_tr_b16 v[60:61], v10 offset:16384
  ds_read_b64_tr_b16 v[62:63], v10 offset:16896
  v_exp_f32 v29, v29
  v_exp_f32 v30, v30
  v_exp_f32 v31, v31
  v_mul_f32 v92, v92, v100
  s_waitcnt lgkmcnt(6)
  v_mfma_f32_32x32x16_bf16 v[108:123], v[68:71], a[76:79], v[108:123]
  ds_read_b64_tr_b16 v[64:65], v11 offset:16384
  ds_read_b64_tr_b16 v[66:67], v11 offset:16896
  v_mul_f32 v93, v93, v101
  v_mul_f32 v94, v94, v102
  v_mul_f32 v95, v95, v103
  v_mul_f32 v96, v96, v104
  v_mfma_f32_32x32x16_bf16 v[124:139], v[72:75], a[76:79], v[124:139]
  ds_read_b64_tr_b16 v[68:69], v10 offset:20480
  ds_read_b64_tr_b16 v[70:71], v10 offset:20992
  v_mul_f32 v97, v97, v105
  v_mul_f32 v98, v98, v106
  v_mul_f32 v99, v99, v107
  v_fma_f32 v24, v24, v23, v23
  s_barrier
  s_waitcnt lgkmcnt(6)
  v_mfma_f32_32x32x16_bf16 v[108:123], v[52:55], a[80:83], v[108:123]
  ds_read_b64_tr_b16 v[72:73], v11 offset:20480
  ds_read_b64_tr_b16 v[74:75], v11 offset:20992
  v_fma_f32 v25, v25, v23, v23
  v_fma_f32 v26, v26, v23, v23
  v_fma_f32 v27, v27, v23, v23
  v_fma_f32 v28, v28, v23, v23
  v_mfma_f32_32x32x16_bf16 v[124:139], v[56:59], a[80:83], v[124:139]
  ds_read_b64_tr_b16 v[52:53], v10 offset:24576
  ds_read_b64_tr_b16 v[54:55], v10 offset:25088
  v_fma_f32 v29, v29, v23, v23
  v_fma_f32 v30, v30, v23, v23
  v_fma_f32 v31, v31, v23, v23
  v_rcp_f32 v24, v24
  s_waitcnt lgkmcnt(6)
  v_mfma_f32_32x32x16_bf16 v[108:123], v[60:63], a[84:87], v[108:123]
  ds_read_b64_tr_b16 v[56:57], v11 offset:24576
  ds_read_b64_tr_b16 v[58:59], v11 offset:25088
  v_rcp_f32 v25, v25
  v_rcp_f32 v26, v26
  v_rcp_f32 v27, v27
  v_rcp_f32 v28, v28
  v_mfma_f32_32x32x16_bf16 v[124:139], v[64:67], a[84:87], v[124:139]
  ds_read_b64_tr_b16 v[60:61], v10 offset:28672
  ds_read_b64_tr_b16 v[62:63], v10 offset:29184
  v_rcp_f32 v29, v29
  v_rcp_f32 v30, v30
  v_rcp_f32 v31, v31
  v_mul_f32 v92, v92, v24
  s_waitcnt lgkmcnt(6)
  v_mfma_f32_32x32x16_bf16 v[108:123], v[68:71], a[88:91], v[108:123]
  ds_read_b64_tr_b16 v[64:65], v11 offset:28672
  ds_read_b64_tr_b16 v[66:67], v11 offset:29184
  v_mul_f32 v93, v93, v25
  v_mul_f32 v94, v94, v26
  v_mul_f32 v95, v95, v27
  v_mul_f32 v96, v96, v28
  v_mfma_f32_32x32x16_bf16 v[124:139], v[72:75], a[88:91], v[124:139]
  ds_read_b64_tr_b16 v[68:69], v10 offset:32768
  ds_read_b64_tr_b16 v[70:71], v10 offset:33280
  v_mul_f32 v97, v97, v29
  v_mul_f32 v98, v98, v30
  v_mul_f32 v99, v99, v31
  v_cvt_pk_bf16_f32 v32, v92, v93
  s_waitcnt lgkmcnt(6)
  v_mfma_f32_32x32x16_bf16 v[108:123], v[52:55], a[92:95], v[108:123]
  ds_read_b64_tr_b16 v[72:73], v11 offset:32768
  ds_read_b64_tr_b16 v[74:75], v11 offset:33280
  v_cvt_pk_bf16_f32 v33, v94, v95
  v_cvt_pk_bf16_f32 v34, v96, v97
  v_cvt_pk_bf16_f32 v35, v98, v99
  s_nop 1
  v_mfma_f32_32x32x16_bf16 v[124:139], v[56:59], a[92:95], v[124:139]
  ds_read_b64_tr_b16 v[52:53], v10 offset:36864
  ds_read_b64_tr_b16 v[54:55], v10 offset:37376
  v_permlane32_swap_b32 v32, v34
  v_permlane32_swap_b32 v33, v35
  buffer_store_dwordx4 v[32:35], v2, s[24:27], s69 offen offset:1024 sc1
  s_nop 1
  s_waitcnt lgkmcnt(6)
  v_mfma_f32_32x32x16_bf16 v[108:123], v[60:63], a[96:99], v[108:123]
  ds_read_b64_tr_b16 v[56:57], v11 offset:36864
  ds_read_b64_tr_b16 v[58:59], v11 offset:37376
  v_mfma_f32_32x32x16_bf16 v[124:139], v[64:67], a[96:99], v[124:139]
  ds_read_b64_tr_b16 v[60:61], v10 offset:40960
  ds_read_b64_tr_b16 v[62:63], v10 offset:41472
  s_waitcnt lgkmcnt(6)
  v_mfma_f32_32x32x16_bf16 v[108:123], v[68:71], a[100:103], v[108:123]
  ds_read_b64_tr_b16 v[64:65], v11 offset:40960
  ds_read_b64_tr_b16 v[66:67], v11 offset:41472
  v_mfma_f32_32x32x16_bf16 v[124:139], v[72:75], a[100:103], v[124:139]
  ds_read_b64_tr_b16 v[68:69], v8 offset:45056
  ds_read_b64_tr_b16 v[70:71], v8 offset:45568
  s_waitcnt lgkmcnt(6)
  v_mfma_f32_32x32x16_bf16 v[108:123], v[52:55], a[104:107], v[108:123]
  ds_read_b64_tr_b16 v[72:73], v9 offset:45056
  ds_read_b64_tr_b16 v[74:75], v9 offset:45568
  v_mfma_f32_32x32x16_bf16 v[124:139], v[56:59], a[104:107], v[124:139]
  ds_read_b64_tr_b16 v[52:53], v8 offset:49152
  ds_read_b64_tr_b16 v[54:55], v8 offset:49664
  s_waitcnt lgkmcnt(6)
  v_mfma_f32_32x32x16_bf16 v[108:123], v[60:63], a[108:111], v[108:123]
  ds_read_b64_tr_b16 v[56:57], v9 offset:49152
  ds_read_b64_tr_b16 v[58:59], v9 offset:49664
  v_mfma_f32_32x32x16_bf16 v[124:139], v[64:67], a[108:111], v[124:139]
  ds_read_b64_tr_b16 v[60:61], v8 offset:53248
  ds_read_b64_tr_b16 v[62:63], v8 offset:53760
  s_barrier
  s_waitcnt lgkmcnt(6)
  v_mfma_f32_32x32x16_bf16 v[76:91], v[68:71], a[0:3], 0
  ds_read_b64_tr_b16 v[64:65], v9 offset:53248
  ds_read_b64_tr_b16 v[66:67], v9 offset:53760
  v_mfma_f32_32x32x16_bf16 v[92:107], v[72:75], a[0:3], 0
  ds_read_b64_tr_b16 v[68:69], v12 offset:32768
  ds_read_b64_tr_b16 v[70:71], v12 offset:33280
  s_waitcnt lgkmcnt(6)
  v_mfma_f32_32x32x16_bf16 v[76:91], v[52:55], a[4:7], v[76:91]
  ds_read_b64_tr_b16 v[72:73], v13 offset:32768
  ds_read_b64_tr_b16 v[74:75], v13 offset:33280
  v_mfma_f32_32x32x16_bf16 v[92:107], v[56:59], a[4:7], v[92:107]
  ds_read_b64_tr_b16 v[52:53], v12 offset:36864
  ds_read_b64_tr_b16 v[54:55], v12 offset:37376
  s_waitcnt lgkmcnt(6)
  v_mfma_f32_32x32x16_bf16 v[76:91], v[60:63], a[8:11], v[76:91]
  ds_read_b64_tr_b16 v[56:57], v13 offset:36864
  ds_read_b64_tr_b16 v[58:59], v13 offset:37376
  v_fmac_f32 v108, v21, v36
  v_fmac_f32 v109, v21, v37
  v_mfma_f32_32x32x16_bf16 v[92:107], v[64:67], a[8:11], v[92:107]
  ds_read_b64_tr_b16 v[60:61], v12 offset:40960
  ds_read_b64_tr_b16 v[62:63], v12 offset:41472
  v_fmac_f32 v110, v21, v38
  v_fmac_f32 v111, v21, v39
  v_fmac_f32 v112, v21, v40
  s_waitcnt lgkmcnt(6)
  v_mfma_f32_32x32x16_bf16 v[76:91], v[68:71], a[12:15], v[76:91]
  ds_read_b64_tr_b16 v[64:65], v13 offset:40960
  ds_read_b64_tr_b16 v[66:67], v13 offset:41472
  v_fmac_f32 v113, v21, v41
  v_fmac_f32 v114, v21, v42
  v_fmac_f32 v115, v21, v43
  v_mfma_f32_32x32x16_bf16 v[92:107], v[72:75], a[12:15], v[92:107]
  ds_read_b64_tr_b16 v[68:69], v12 offset:45056
  ds_read_b64_tr_b16 v[70:71], v12 offset:45568
  v_fmac_f32 v116, v21, v44
  v_fmac_f32 v117, v21, v45
  v_fmac_f32 v118, v21, v46
  s_waitcnt lgkmcnt(6)
  v_mfma_f32_32x32x16_bf16 v[76:91], v[52:55], a[16:19], v[76:91]
  ds_read_b64_tr_b16 v[72:73], v13 offset:45056
  ds_read_b64_tr_b16 v[74:75], v13 offset:45568
  v_fmac_f32 v119, v21, v47
  v_fmac_f32 v120, v21, v48
  v_fmac_f32 v121, v21, v49
  v_mfma_f32_32x32x16_bf16 v[92:107], v[56:59], a[16:19], v[92:107]
  ds_read_b64_tr_b16 v[52:53], v12 offset:49152
  ds_read_b64_tr_b16 v[54:55], v12 offset:49664
  v_fmac_f32 v122, v21, v50
  v_fmac_f32 v123, v21, v51
  ds_read_b128 v[36:39], v20 offset:192
  s_waitcnt lgkmcnt(7)
  v_mfma_f32_32x32x16_bf16 v[76:91], v[60:63], a[20:23], v[76:91]
  ds_read_b64_tr_b16 v[56:57], v13 offset:49152
  ds_read_b64_tr_b16 v[58:59], v13 offset:49664
  ds_read_b128 v[40:43], v20 offset:224
  ds_read_b128 v[44:47], v20 offset:704
  ds_read_b128 v[48:51], v20 offset:736
  v_mfma_f32_32x32x16_bf16 v[92:107], v[64:67], a[20:23], v[92:107]
  ds_read_b64_tr_b16 v[60:61], v12 offset:53248
  ds_read_b64_tr_b16 v[62:63], v12 offset:53760
  v_mul_f32 v24, v22, v108
  v_mul_f32 v25, v22, v109
  v_mul_f32 v26, v22, v110
  s_waitcnt lgkmcnt(10)
  v_mfma_f32_32x32x16_bf16 v[76:91], v[68:71], a[24:27], v[76:91]
  ds_read_b64_tr_b16 v[64:65], v13 offset:53248
  ds_read_b64_tr_b16 v[66:67], v13 offset:53760
  v_mul_f32 v27, v22, v111
  v_mul_f32 v28, v22, v112
  v_mul_f32 v29, v22, v113
  v_mfma_f32_32x32x16_bf16 v[92:107], v[72:75], a[24:27], v[92:107]
  ds_read_b64_tr_b16 v[68:69], v12 offset:57344
  ds_read_b64_tr_b16 v[70:71], v12 offset:57856
  v_mul_f32 v30, v22, v114
  v_mul_f32 v31, v22, v115
  v_exp_f32 v24, v24
  s_waitcnt lgkmcnt(9)
  v_mfma_f32_32x32x16_bf16 v[76:91], v[52:55], a[28:31], v[76:91]
  ds_read_b64_tr_b16 v[72:73], v13 offset:57344
  ds_read_b64_tr_b16 v[74:75], v13 offset:57856
  v_exp_f32 v25, v25
  v_exp_f32 v26, v26
  v_exp_f32 v27, v27
  v_mfma_f32_32x32x16_bf16 v[92:107], v[56:59], a[28:31], v[92:107]
  ds_read_b64_tr_b16 v[52:53], v12 offset:61440
  ds_read_b64_tr_b16 v[54:55], v12 offset:61952
  v_exp_f32 v28, v28
  v_exp_f32 v29, v29
  v_exp_f32 v30, v30
  s_barrier
  s_waitcnt lgkmcnt(6)
  v_mfma_f32_32x32x16_bf16 v[76:91], v[60:63], a[32:35], v[76:91]
  ds_read_b64_tr_b16 v[56:57], v13 offset:61440
  ds_read_b64_tr_b16 v[58:59], v13 offset:61952
  v_exp_f32 v31, v31
  v_mul_f32 v108, v108, v116
  v_mul_f32 v109, v109, v117
  v_mfma_f32_32x32x16_bf16 v[92:107], v[64:67], a[32:35], v[92:107]
  ds_read_b64_tr_b16 v[60:61], v8 offset:57344
  ds_read_b64_tr_b16 v[62:63], v8 offset:57856
  v_mul_f32 v110, v110, v118
  v_mul_f32 v111, v111, v119
  v_mul_f32 v112, v112, v120
  s_waitcnt lgkmcnt(6)
  v_mfma_f32_32x32x16_bf16 v[76:91], v[68:71], a[36:39], v[76:91]
  ds_read_b64_tr_b16 v[64:65], v9 offset:57344
  ds_read_b64_tr_b16 v[66:67], v9 offset:57856
  v_mul_f32 v113, v113, v121
  v_mul_f32 v114, v114, v122
  v_mul_f32 v115, v115, v123
  v_mfma_f32_32x32x16_bf16 v[92:107], v[72:75], a[36:39], v[92:107]
  ds_read_b64_tr_b16 v[68:69], v8 offset:61440
  ds_read_b64_tr_b16 v[70:71], v8 offset:61952
  v_fma_f32 v24, v24, v23, v23
  v_fma_f32 v25, v25, v23, v23
  v_fma_f32 v26, v26, v23, v23
  s_waitcnt lgkmcnt(6)
  v_mfma_f32_32x32x16_bf16 v[76:91], v[52:55], a[40:43], v[76:91]
  ds_read_b64_tr_b16 v[72:73], v9 offset:61440
  ds_read_b64_tr_b16 v[74:75], v9 offset:61952
  v_fma_f32 v27, v27, v23, v23
  v_fma_f32 v28, v28, v23, v23
  v_fma_f32 v29, v29, v23, v23
  v_mfma_f32_32x32x16_bf16 v[92:107], v[56:59], a[40:43], v[92:107]
  ds_read_b64_tr_b16 v[52:53], v12 offset:0
  ds_read_b64_tr_b16 v[54:55], v12 offset:512
  v_fma_f32 v30, v30, v23, v23
  v_fma_f32 v31, v31, v23, v23
  v_rcp_f32 v24, v24
  s_waitcnt lgkmcnt(6)
  v_mfma_f32_32x32x16_bf16 v[76:91], v[60:63], a[44:47], v[76:91]
  ds_read_b64_tr_b16 v[56:57], v13 offset:0
  ds_read_b64_tr_b16 v[58:59], v13 offset:512
  v_rcp_f32 v25, v25
  v_rcp_f32 v26, v26
  v_rcp_f32 v27, v27
  v_mfma_f32_32x32x16_bf16 v[92:107], v[64:67], a[44:47], v[92:107]
  ds_read_b64_tr_b16 v[60:61], v16 offset:0
  ds_read_b64_tr_b16 v[62:63], v16 offset:512
  v_rcp_f32 v28, v28
  v_rcp_f32 v29, v29
  v_rcp_f32 v30, v30
  s_waitcnt lgkmcnt(6)
  v_mfma_f32_32x32x16_bf16 v[76:91], v[68:71], a[48:51], v[76:91]
  ds_read_b64_tr_b16 v[64:65], v17 offset:0
  ds_read_b64_tr_b16 v[66:67], v17 offset:512
  v_rcp_f32 v31, v31
  v_mul_f32 v108, v108, v24
  v_mul_f32 v109, v109, v25
  v_mfma_f32_32x32x16_bf16 v[92:107], v[72:75], a[48:51], v[92:107]
  ds_read_b64_tr_b16 v[68:69], v16 offset:4096
  ds_read_b64_tr_b16 v[70:71], v16 offset:4608
  v_mul_f32 v110, v110, v26
  v_mul_f32 v111, v111, v27
  v_mul_f32 v112, v112, v28
  s_waitcnt lgkmcnt(6)
  v_mfma_f32_32x32x16_bf16 v[76:91], v[52:55], a[52:55], v[76:91]
  ds_read_b64_tr_b16 v[72:73], v17 offset:4096
  ds_read_b64_tr_b16 v[74:75], v17 offset:4608
  v_mul_f32 v113, v113, v29
  v_mul_f32 v114, v114, v30
  v_mul_f32 v115, v115, v31
  v_mfma_f32_32x32x16_bf16 v[92:107], v[56:59], a[52:55], v[92:107]
  ds_read_b64_tr_b16 v[52:53], v16 offset:8192
  ds_read_b64_tr_b16 v[54:55], v16 offset:8704
  v_cvt_pk_bf16_f32 v32, v108, v109
  v_cvt_pk_bf16_f32 v33, v110, v111
  v_cvt_pk_bf16_f32 v34, v112, v113
  s_waitcnt lgkmcnt(6)
  v_mfma_f32_32x32x16_bf16 v[76:91], v[60:63], a[56:59], v[76:91]
  ds_read_b64_tr_b16 v[56:57], v17 offset:8192
  ds_read_b64_tr_b16 v[58:59], v17 offset:8704
  v_cvt_pk_bf16_f32 v35, v114, v115
  s_nop 1
  v_permlane32_swap_b32 v32, v34
  v_mfma_f32_32x32x16_bf16 v[92:107], v[64:67], a[56:59], v[92:107]
  ds_read_b64_tr_b16 v[60:61], v16 offset:12288
  ds_read_b64_tr_b16 v[62:63], v16 offset:12800
  v_permlane32_swap_b32 v33, v35
  buffer_store_dwordx4 v[32:35], v2, s[24:27], s69 offen offset:2048 sc1
  s_nop 1
  s_waitcnt lgkmcnt(6)
  v_mfma_f32_32x32x16_bf16 v[76:91], v[68:71], a[60:63], v[76:91]
  ds_read_b64_tr_b16 v[64:65], v17 offset:12288
  ds_read_b64_tr_b16 v[66:67], v17 offset:12800
  v_fmac_f32 v124, v21, v36
  v_fmac_f32 v125, v21, v37
  v_mfma_f32_32x32x16_bf16 v[92:107], v[72:75], a[60:63], v[92:107]
  ds_read_b64_tr_b16 v[68:69], v16 offset:16384
  ds_read_b64_tr_b16 v[70:71], v16 offset:16896
  v_fmac_f32 v126, v21, v38
  v_fmac_f32 v127, v21, v39
  v_fmac_f32 v128, v21, v40
  s_barrier
  s_waitcnt lgkmcnt(6)
  v_mfma_f32_32x32x16_bf16 v[76:91], v[52:55], a[64:67], v[76:91]
  ds_read_b64_tr_b16 v[72:73], v17 offset:16384
  ds_read_b64_tr_b16 v[74:75], v17 offset:16896
  v_fmac_f32 v129, v21, v41
  v_fmac_f32 v130, v21, v42
  v_fmac_f32 v131, v21, v43
  v_mfma_f32_32x32x16_bf16 v[92:107], v[56:59], a[64:67], v[92:107]
  ds_read_b64_tr_b16 v[52:53], v16 offset:20480
  ds_read_b64_tr_b16 v[54:55], v16 offset:20992
  v_fmac_f32 v132, v21, v44
  v_fmac_f32 v133, v21, v45
  v_fmac_f32 v134, v21, v46
  s_waitcnt lgkmcnt(6)
  v_mfma_f32_32x32x16_bf16 v[76:91], v[60:63], a[68:71], v[76:91]
  ds_read_b64_tr_b16 v[56:57], v17 offset:20480
  ds_read_b64_tr_b16 v[58:59], v17 offset:20992
  v_fmac_f32 v135, v21, v47
  v_fmac_f32 v136, v21, v48
  v_fmac_f32 v137, v21, v49
  v_mfma_f32_32x32x16_bf16 v[92:107], v[64:67], a[68:71], v[92:107]
  ds_read_b64_tr_b16 v[60:61], v16 offset:24576
  ds_read_b64_tr_b16 v[62:63], v16 offset:25088
  v_fmac_f32 v138, v21, v50
  v_fmac_f32 v139, v21, v51
  ds_read_b128 v[36:39], v20 offset:256
  s_waitcnt lgkmcnt(7)
  v_mfma_f32_32x32x16_bf16 v[76:91], v[68:71], a[72:75], v[76:91]
  ds_read_b64_tr_b16 v[64:65], v17 offset:24576
  ds_read_b64_tr_b16 v[66:67], v17 offset:25088
  ds_read_b128 v[40:43], v20 offset:288
  ds_read_b128 v[44:47], v20 offset:768
  ds_read_b128 v[48:51], v20 offset:800
  v_mfma_f32_32x32x16_bf16 v[92:107], v[72:75], a[72:75], v[92:107]
  ds_read_b64_tr_b16 v[68:69], v12 offset:4096
  ds_read_b64_tr_b16 v[70:71], v12 offset:4608
  v_mul_f32 v24, v22, v124
  v_mul_f32 v25, v22, v125
  v_mul_f32 v26, v22, v126
  s_waitcnt lgkmcnt(10)
  v_mfma_f32_32x32x16_bf16 v[76:91], v[52:55], a[76:79], v[76:91]
  ds_read_b64_tr_b16 v[72:73], v13 offset:4096
  ds_read_b64_tr_b16 v[74:75], v13 offset:4608
  v_mul_f32 v27, v22, v127
  v_mul_f32 v28, v22, v128
  v_mul_f32 v29, v22, v129
  v_mfma_f32_32x32x16_bf16 v[92:107], v[56:59], a[76:79], v[92:107]
  ds_read_b64_tr_b16 v[52:53], v12 offset:8192
  ds_read_b64_tr_b16 v[54:55], v12 offset:8704
  v_mul_f32 v30, v22, v130
  v_mul_f32 v31, v22, v131
  v_exp_f32 v24, v24
  s_waitcnt lgkmcnt(9)
  v_mfma_f32_32x32x16_bf16 v[76:91], v[60:63], a[80:83], v[76:91]
  ds_read_b64_tr_b16 v[56:57], v13 offset:8192
  ds_read_b64_tr_b16 v[58:59], v13 offset:8704
  v_exp_f32 v25, v25
  v_exp_f32 v26, v26
  v_exp_f32 v27, v27
  v_mfma_f32_32x32x16_bf16 v[92:107], v[64:67], a[80:83], v[92:107]
  ds_read_b64_tr_b16 v[60:61], v12 offset:12288
  ds_read_b64_tr_b16 v[62:63], v12 offset:12800
  v_exp_f32 v28, v28
  v_exp_f32 v29, v29
  v_exp_f32 v30, v30
  s_waitcnt lgkmcnt(6)
  v_mfma_f32_32x32x16_bf16 v[76:91], v[68:71], a[84:87], v[76:91]
  ds_read_b64_tr_b16 v[64:65], v13 offset:12288
  ds_read_b64_tr_b16 v[66:67], v13 offset:12800
  v_exp_f32 v31, v31
  v_mul_f32 v124, v124, v132
  v_mul_f32 v125, v125, v133
  v_mfma_f32_32x32x16_bf16 v[92:107], v[72:75], a[84:87], v[92:107]
  ds_read_b64_tr_b16 v[68:69], v12 offset:16384
  ds_read_b64_tr_b16 v[70:71], v12 offset:16896
  v_mul_f32 v126, v126, v134
  v_mul_f32 v127, v127, v135
  v_mul_f32 v128, v128, v136
  s_waitcnt lgkmcnt(6)
  v_mfma_f32_32x32x16_bf16 v[76:91], v[52:55], a[88:91], v[76:91]
  ds_read_b64_tr_b16 v[72:73], v13 offset:16384
  ds_read_b64_tr_b16 v[74:75], v13 offset:16896
  v_mul_f32 v129, v129, v137
  v_mul_f32 v130, v130, v138
  v_mul_f32 v131, v131, v139
  v_mfma_f32_32x32x16_bf16 v[92:107], v[56:59], a[88:91], v[92:107]
  ds_read_b64_tr_b16 v[52:53], v12 offset:20480
  ds_read_b64_tr_b16 v[54:55], v12 offset:20992
  v_fma_f32 v24, v24, v23, v23
  v_fma_f32 v25, v25, v23, v23
  v_fma_f32 v26, v26, v23, v23
  s_waitcnt lgkmcnt(6)
  v_mfma_f32_32x32x16_bf16 v[76:91], v[60:63], a[92:95], v[76:91]
  ds_read_b64_tr_b16 v[56:57], v13 offset:20480
  ds_read_b64_tr_b16 v[58:59], v13 offset:20992
  v_fma_f32 v27, v27, v23, v23
  v_fma_f32 v28, v28, v23, v23
  v_fma_f32 v29, v29, v23, v23
  v_mfma_f32_32x32x16_bf16 v[92:107], v[64:67], a[92:95], v[92:107]
  ds_read_b64_tr_b16 v[60:61], v12 offset:24576
  ds_read_b64_tr_b16 v[62:63], v12 offset:25088
  v_fma_f32 v30, v30, v23, v23
  v_fma_f32 v31, v31, v23, v23
  v_rcp_f32 v24, v24
  s_barrier
  s_waitcnt lgkmcnt(6)
  v_mfma_f32_32x32x16_bf16 v[76:91], v[68:71], a[96:99], v[76:91]
  ds_read_b64_tr_b16 v[64:65], v13 offset:24576
  ds_read_b64_tr_b16 v[66:67], v13 offset:25088
  v_rcp_f32 v25, v25
  v_rcp_f32 v26, v26
  v_rcp_f32 v27, v27
  v_mfma_f32_32x32x16_bf16 v[92:107], v[72:75], a[96:99], v[92:107]
  ds_read_b64_tr_b16 v[68:69], v12 offset:28672
  ds_read_b64_tr_b16 v[70:71], v12 offset:29184
  v_rcp_f32 v28, v28
  v_rcp_f32 v29, v29
  v_rcp_f32 v30, v30
  s_waitcnt lgkmcnt(6)
  v_mfma_f32_32x32x16_bf16 v[76:91], v[52:55], a[100:103], v[76:91]
  ds_read_b64_tr_b16 v[72:73], v13 offset:28672
  ds_read_b64_tr_b16 v[74:75], v13 offset:29184
  v_rcp_f32 v31, v31
  v_mul_f32 v124, v124, v24
  v_mul_f32 v125, v125, v25
  v_mfma_f32_32x32x16_bf16 v[92:107], v[56:59], a[100:103], v[92:107]
  ds_read_b64_tr_b16 v[52:53], v10 offset:45056
  ds_read_b64_tr_b16 v[54:55], v10 offset:45568
  v_mul_f32 v126, v126, v26
  v_mul_f32 v127, v127, v27
  v_mul_f32 v128, v128, v28
  s_waitcnt lgkmcnt(6)
  v_mfma_f32_32x32x16_bf16 v[76:91], v[60:63], a[104:107], v[76:91]
  ds_read_b64_tr_b16 v[56:57], v11 offset:45056
  ds_read_b64_tr_b16 v[58:59], v11 offset:45568
  v_mul_f32 v129, v129, v29
  v_mul_f32 v130, v130, v30
  v_mul_f32 v131, v131, v31
  v_mfma_f32_32x32x16_bf16 v[92:107], v[64:67], a[104:107], v[92:107]
  ds_read_b64_tr_b16 v[60:61], v10 offset:49152
  ds_read_b64_tr_b16 v[62:63], v10 offset:49664
  v_cvt_pk_bf16_f32 v32, v124, v125
  v_cvt_pk_bf16_f32 v33, v126, v127
  v_cvt_pk_bf16_f32 v34, v128, v129
  s_waitcnt lgkmcnt(6)
  v_mfma_f32_32x32x16_bf16 v[76:91], v[68:71], a[108:111], v[76:91]
  ds_read_b64_tr_b16 v[64:65], v11 offset:49152
  ds_read_b64_tr_b16 v[66:67], v11 offset:49664
  v_cvt_pk_bf16_f32 v35, v130, v131
  s_nop 1
  v_permlane32_swap_b32 v32, v34
  v_mfma_f32_32x32x16_bf16 v[92:107], v[72:75], a[108:111], v[92:107]
  ds_read_b64_tr_b16 v[68:69], v10 offset:53248
  ds_read_b64_tr_b16 v[70:71], v10 offset:53760
  v_permlane32_swap_b32 v33, v35
  buffer_store_dwordx4 v[32:35], v2, s[24:27], s69 offen offset:3072 sc1
  s_nop 1
  s_waitcnt lgkmcnt(6)
  v_mfma_f32_32x32x16_bf16 v[108:123], v[52:55], a[0:3], 0
  ds_read_b64_tr_b16 v[72:73], v11 offset:53248
  ds_read_b64_tr_b16 v[74:75], v11 offset:53760
  v_mfma_f32_32x32x16_bf16 v[124:139], v[56:59], a[0:3], 0
  ds_read_b64_tr_b16 v[52:53], v14 offset:32768
  ds_read_b64_tr_b16 v[54:55], v14 offset:33280
  s_waitcnt lgkmcnt(6)
  v_mfma_f32_32x32x16_bf16 v[108:123], v[60:63], a[4:7], v[108:123]
  ds_read_b64_tr_b16 v[56:57], v15 offset:32768
  ds_read_b64_tr_b16 v[58:59], v15 offset:33280
  v_mfma_f32_32x32x16_bf16 v[124:139], v[64:67], a[4:7], v[124:139]
  ds_read_b64_tr_b16 v[60:61], v14 offset:36864
  ds_read_b64_tr_b16 v[62:63], v14 offset:37376
  s_waitcnt lgkmcnt(6)
  v_mfma_f32_32x32x16_bf16 v[108:123], v[68:71], a[8:11], v[108:123]
  ds_read_b64_tr_b16 v[64:65], v15 offset:36864
  ds_read_b64_tr_b16 v[66:67], v15 offset:37376
  v_fmac_f32 v76, v21, v36
  v_fmac_f32 v77, v21, v37
  v_mfma_f32_32x32x16_bf16 v[124:139], v[72:75], a[8:11], v[124:139]
  ds_read_b64_tr_b16 v[68:69], v14 offset:40960
  ds_read_b64_tr_b16 v[70:71], v14 offset:41472
  v_fmac_f32 v78, v21, v38
  v_fmac_f32 v79, v21, v39
  v_fmac_f32 v80, v21, v40
  s_waitcnt lgkmcnt(6)
  v_mfma_f32_32x32x16_bf16 v[108:123], v[52:55], a[12:15], v[108:123]
  ds_read_b64_tr_b16 v[72:73], v15 offset:40960
  ds_read_b64_tr_b16 v[74:75], v15 offset:41472
  v_fmac_f32 v81, v21, v41
  v_fmac_f32 v82, v21, v42
  v_fmac_f32 v83, v21, v43
  v_mfma_f32_32x32x16_bf16 v[124:139], v[56:59], a[12:15], v[124:139]
  ds_read_b64_tr_b16 v[52:53], v14 offset:45056
  ds_read_b64_tr_b16 v[54:55], v14 offset:45568
  v_fmac_f32 v84, v21, v44
  v_fmac_f32 v85, v21, v45
  v_fmac_f32 v86, v21, v46
  s_barrier
  s_waitcnt lgkmcnt(6)
  v_mfma_f32_32x32x16_bf16 v[108:123], v[60:63], a[16:19], v[108:123]
  ds_read_b64_tr_b16 v[56:57], v15 offset:45056
  ds_read_b64_tr_b16 v[58:59], v15 offset:45568
  v_fmac_f32 v87, v21, v47
  v_fmac_f32 v88, v21, v48
  v_fmac_f32 v89, v21, v49
  v_mfma_f32_32x32x16_bf16 v[124:139], v[64:67], a[16:19], v[124:139]
  ds_read_b64_tr_b16 v[60:61], v14 offset:49152
  ds_read_b64_tr_b16 v[62:63], v14 offset:49664
  v_fmac_f32 v90, v21, v50
  v_fmac_f32 v91, v21, v51
  ds_read_b128 v[36:39], v20 offset:320
  s_waitcnt lgkmcnt(7)
  v_mfma_f32_32x32x16_bf16 v[108:123], v[68:71], a[20:23], v[108:123]
  ds_read_b64_tr_b16 v[64:65], v15 offset:49152
  ds_read_b64_tr_b16 v[66:67], v15 offset:49664
  ds_read_b128 v[40:43], v20 offset:352
  ds_read_b128 v[44:47], v20 offset:832
  ds_read_b128 v[48:51], v20 offset:864
  v_mfma_f32_32x32x16_bf16 v[124:139], v[72:75], a[20:23], v[124:139]
  ds_read_b64_tr_b16 v[68:69], v14 offset:53248
  ds_read_b64_tr_b16 v[70:71], v14 offset:53760
  v_mul_f32 v24, v22, v76
  v_mul_f32 v25, v22, v77
  v_mul_f32 v26, v22, v78
  s_waitcnt lgkmcnt(10)
  v_mfma_f32_32x32x16_bf16 v[108:123], v[52:55], a[24:27], v[108:123]
  ds_read_b64_tr_b16 v[72:73], v15 offset:53248
  ds_read_b64_tr_b16 v[74:75], v15 offset:53760
  v_mul_f32 v27, v22, v79
  v_mul_f32 v28, v22, v80
  v_mul_f32 v29, v22, v81
  v_mfma_f32_32x32x16_bf16 v[124:139], v[56:59], a[24:27], v[124:139]
  ds_read_b64_tr_b16 v[52:53], v14 offset:57344
  ds_read_b64_tr_b16 v[54:55], v14 offset:57856
  v_mul_f32 v30, v22, v82
  v_mul_f32 v31, v22, v83
  v_exp_f32 v24, v24
  s_waitcnt lgkmcnt(9)
  v_mfma_f32_32x32x16_bf16 v[108:123], v[60:63], a[28:31], v[108:123]
  ds_read_b64_tr_b16 v[56:57], v15 offset:57344
  ds_read_b64_tr_b16 v[58:59], v15 offset:57856
  v_exp_f32 v25, v25
  v_exp_f32 v26, v26
  v_exp_f32 v27, v27
  v_mfma_f32_32x32x16_bf16 v[124:139], v[64:67], a[28:31], v[124:139]
  ds_read_b64_tr_b16 v[60:61], v14 offset:61440
  ds_read_b64_tr_b16 v[62:63], v14 offset:61952
  v_exp_f32 v28, v28
  v_exp_f32 v29, v29
  v_exp_f32 v30, v30
  s_waitcnt lgkmcnt(6)
  v_mfma_f32_32x32x16_bf16 v[108:123], v[68:71], a[32:35], v[108:123]
  ds_read_b64_tr_b16 v[64:65], v15 offset:61440
  ds_read_b64_tr_b16 v[66:67], v15 offset:61952
  v_exp_f32 v31, v31
  v_mul_f32 v76, v76, v84
  v_mul_f32 v77, v77, v85
  v_mfma_f32_32x32x16_bf16 v[124:139], v[72:75], a[32:35], v[124:139]
  ds_read_b64_tr_b16 v[68:69], v10 offset:57344
  ds_read_b64_tr_b16 v[70:71], v10 offset:57856
  v_mul_f32 v78, v78, v86
  v_mul_f32 v79, v79, v87
  v_mul_f32 v80, v80, v88
  s_waitcnt lgkmcnt(6)
  v_mfma_f32_32x32x16_bf16 v[108:123], v[52:55], a[36:39], v[108:123]
  ds_read_b64_tr_b16 v[72:73], v11 offset:57344
  ds_read_b64_tr_b16 v[74:75], v11 offset:57856
  v_mul_f32 v81, v81, v89
  v_mul_f32 v82, v82, v90
  v_mul_f32 v83, v83, v91
  v_mfma_f32_32x32x16_bf16 v[124:139], v[56:59], a[36:39], v[124:139]
  ds_read_b64_tr_b16 v[52:53], v10 offset:61440
  ds_read_b64_tr_b16 v[54:55], v10 offset:61952
  v_fma_f32 v24, v24, v23, v23
  v_fma_f32 v25, v25, v23, v23
  v_fma_f32 v26, v26, v23, v23
  s_waitcnt lgkmcnt(6)
  v_mfma_f32_32x32x16_bf16 v[108:123], v[60:63], a[40:43], v[108:123]
  ds_read_b64_tr_b16 v[56:57], v11 offset:61440
  ds_read_b64_tr_b16 v[58:59], v11 offset:61952
  v_fma_f32 v27, v27, v23, v23
  v_fma_f32 v28, v28, v23, v23
  v_fma_f32 v29, v29, v23, v23
  v_mfma_f32_32x32x16_bf16 v[124:139], v[64:67], a[40:43], v[124:139]
  ds_read_b64_tr_b16 v[60:61], v14 offset:0
  ds_read_b64_tr_b16 v[62:63], v14 offset:512
  v_fma_f32 v30, v30, v23, v23
  v_fma_f32 v31, v31, v23, v23
  v_rcp_f32 v24, v24
  s_waitcnt lgkmcnt(6)
  v_mfma_f32_32x32x16_bf16 v[108:123], v[68:71], a[44:47], v[108:123]
  ds_read_b64_tr_b16 v[64:65], v15 offset:0
  ds_read_b64_tr_b16 v[66:67], v15 offset:512
  v_rcp_f32 v25, v25
  v_rcp_f32 v26, v26
  v_rcp_f32 v27, v27
  v_mfma_f32_32x32x16_bf16 v[124:139], v[72:75], a[44:47], v[124:139]
  ds_read_b64_tr_b16 v[68:69], v18 offset:0
  ds_read_b64_tr_b16 v[70:71], v18 offset:512
  v_rcp_f32 v28, v28
  v_rcp_f32 v29, v29
  v_rcp_f32 v30, v30
  s_waitcnt vmcnt(0)
  s_barrier
  s_cmp_lg_u32 s52, 0
  s_cbranch_scc1 Lpub_19
  s_add_u32 s56, s12, 0x8000
  buffer_store_dword v140, v141, s[24:27], s56 offen
  buffer_store_dword v140, v141, s[24:27], s12 offen sc0 sc1
Lpub_19:
  s_waitcnt lgkmcnt(6)
  v_mfma_f32_32x32x16_bf16 v[108:123], v[52:55], a[48:51], v[108:123]
  ds_read_b64_tr_b16 v[72:73], v19 offset:0
  ds_read_b64_tr_b16 v[74:75], v19 offset:512
  v_rcp_f32 v31, v31
  v_mul_f32 v76, v76, v24
  v_mul_f32 v77, v77, v25
  v_mfma_f32_32x32x16_bf16 v[124:139], v[56:59], a[48:51], v[124:139]
  ds_read_b64_tr_b16 v[52:53], v18 offset:4096
  ds_read_b64_tr_b16 v[54:55], v18 offset:4608
  v_mul_f32 v78, v78, v26
  v_mul_f32 v79, v79, v27
  v_mul_f32 v80, v80, v28
  s_waitcnt lgkmcnt(6)
  v_mfma_f32_32x32x16_bf16 v[108:123], v[60:63], a[52:55], v[108:123]
  ds_read_b64_tr_b16 v[56:57], v19 offset:4096
  ds_read_b64_tr_b16 v[58:59], v19 offset:4608
  v_mul_f32 v81, v81, v29
  v_mul_f32 v82, v82, v30
  v_mul_f32 v83, v83, v31
  v_mfma_f32_32x32x16_bf16 v[124:139], v[64:67], a[52:55], v[124:139]
  ds_read_b64_tr_b16 v[60:61], v18 offset:8192
  ds_read_b64_tr_b16 v[62:63], v18 offset:8704
  v_cvt_pk_bf16_f32 v32, v76, v77
  v_cvt_pk_bf16_f32 v33, v78, v79
  v_cvt_pk_bf16_f32 v34, v80, v81
  s_waitcnt lgkmcnt(6)
  v_mfma_f32_32x32x16_bf16 v[108:123], v[68:71], a[56:59], v[108:123]
  ds_read_b64_tr_b16 v[64:65], v19 offset:8192
  ds_read_b64_tr_b16 v[66:67], v19 offset:8704
  v_cvt_pk_bf16_f32 v35, v82, v83
  s_nop 1
  v_permlane32_swap_b32 v32, v34
  v_mfma_f32_32x32x16_bf16 v[124:139], v[72:75], a[56:59], v[124:139]
  ds_read_b64_tr_b16 v[68:69], v18 offset:12288
  ds_read_b64_tr_b16 v[70:71], v18 offset:12800
  v_permlane32_swap_b32 v33, v35
  buffer_store_dwordx4 v[32:35], v2, s[24:27], s70 offen offset:0 sc1
  s_nop 1
  s_waitcnt lgkmcnt(6)
  v_mfma_f32_32x32x16_bf16 v[108:123], v[52:55], a[60:63], v[108:123]
  ds_read_b64_tr_b16 v[72:73], v19 offset:12288
  ds_read_b64_tr_b16 v[74:75], v19 offset:12800
  v_fmac_f32 v92, v21, v36
  v_fmac_f32 v93, v21, v37
  v_mfma_f32_32x32x16_bf16 v[124:139], v[56:59], a[60:63], v[124:139]
  ds_read_b64_tr_b16 v[52:53], v18 offset:16384
  ds_read_b64_tr_b16 v[54:55], v18 offset:16896
  v_fmac_f32 v94, v21, v38
  v_fmac_f32 v95, v21, v39
  v_fmac_f32 v96, v21, v40
  s_waitcnt lgkmcnt(6)
  v_mfma_f32_32x32x16_bf16 v[108:123], v[60:63], a[64:67], v[108:123]
  ds_read_b64_tr_b16 v[56:57], v19 offset:16384
  ds_read_b64_tr_b16 v[58:59], v19 offset:16896
  v_fmac_f32 v97, v21, v41
  v_fmac_f32 v98, v21, v42
  v_fmac_f32 v99, v21, v43
  v_mfma_f32_32x32x16_bf16 v[124:139], v[64:67], a[64:67], v[124:139]
  ds_read_b64_tr_b16 v[60:61], v18 offset:20480
  ds_read_b64_tr_b16 v[62:63], v18 offset:20992
  v_fmac_f32 v100, v21, v44
  v_fmac_f32 v101, v21, v45
  v_fmac_f32 v102, v21, v46
  s_waitcnt lgkmcnt(6)
  v_mfma_f32_32x32x16_bf16 v[108:123], v[68:71], a[68:71], v[108:123]
  ds_read_b64_tr_b16 v[64:65], v19 offset:20480
  ds_read_b64_tr_b16 v[66:67], v19 offset:20992
  v_fmac_f32 v103, v21, v47
  v_fmac_f32 v104, v21, v48
  v_fmac_f32 v105, v21, v49
  v_mfma_f32_32x32x16_bf16 v[124:139], v[72:75], a[68:71], v[124:139]
  ds_read_b64_tr_b16 v[68:69], v18 offset:24576
  ds_read_b64_tr_b16 v[70:71], v18 offset:25088
  v_fmac_f32 v106, v21, v50
  v_fmac_f32 v107, v21, v51
  ds_read_b128 v[36:39], v20 offset:384
  s_waitcnt lgkmcnt(7)
  v_mfma_f32_32x32x16_bf16 v[108:123], v[52:55], a[72:75], v[108:123]
  ds_read_b64_tr_b16 v[72:73], v19 offset:24576
  ds_read_b64_tr_b16 v[74:75], v19 offset:25088
  ds_read_b128 v[40:43], v20 offset:416
  ds_read_b128 v[44:47], v20 offset:896
  ds_read_b128 v[48:51], v20 offset:928
  v_mfma_f32_32x32x16_bf16 v[124:139], v[56:59], a[72:75], v[124:139]
  ds_read_b64_tr_b16 v[52:53], v14 offset:4096
  ds_read_b64_tr_b16 v[54:55], v14 offset:4608
  v_mul_f32 v24, v22, v92
  v_mul_f32 v25, v22, v93
  v_mul_f32 v26, v22, v94
  s_waitcnt lgkmcnt(10)
  v_mfma_f32_32x32x16_bf16 v[108:123], v[60:63], a[76:79], v[108:123]
  ds_read_b64_tr_b16 v[56:57], v15 offset:4096
  ds_read_b64_tr_b16 v[58:59], v15 offset:4608
  v_mul_f32 v27, v22, v95
  v_mul_f32 v28, v22, v96
  v_mul_f32 v29, v22, v97
  v_mfma_f32_32x32x16_bf16 v[124:139], v[64:67], a[76:79], v[124:139]
  ds_read_b64_tr_b16 v[60:61], v14 offset:8192
  ds_read_b64_tr_b16 v[62:63], v14 offset:8704
  v_mul_f32 v30, v22, v98
  v_mul_f32 v31, v22, v99
  v_exp_f32 v24, v24
  s_barrier
  s_waitcnt lgkmcnt(9)
  v_mfma_f32_32x32x16_bf16 v[108:123], v[68:71], a[80:83], v[108:123]
  ds_read_b64_tr_b16 v[64:65], v15 offset:8192
  ds_read_b64_tr_b16 v[66:67], v15 offset:8704
  v_exp_f32 v25, v25
  v_exp_f32 v26, v26
  v_exp_f32 v27, v27
  v_mfma_f32_32x32x16_bf16 v[124:139], v[72:75], a[80:83], v[124:139]
  ds_read_b64_tr_b16 v[68:69], v14 offset:12288
  ds_read_b64_tr_b16 v[70:71], v14 offset:12800
  v_exp_f32 v28, v28
  v_exp_f32 v29, v29
  v_exp_f32 v30, v30
  s_waitcnt lgkmcnt(6)
  v_mfma_f32_32x32x16_bf16 v[108:123], v[52:55], a[84:87], v[108:123]
  ds_read_b64_tr_b16 v[72:73], v15 offset:12288
  ds_read_b64_tr_b16 v[74:75], v15 offset:12800
  v_exp_f32 v31, v31
  v_mul_f32 v92, v92, v100
  v_mul_f32 v93, v93, v101
  v_mfma_f32_32x32x16_bf16 v[124:139], v[56:59], a[84:87], v[124:139]
  ds_read_b64_tr_b16 v[52:53], v14 offset:16384
  ds_read_b64_tr_b16 v[54:55], v14 offset:16896
  v_mul_f32 v94, v94, v102
  v_mul_f32 v95, v95, v103
  v_mul_f32 v96, v96, v104
  s_waitcnt lgkmcnt(6)
  v_mfma_f32_32x32x16_bf16 v[108:123], v[60:63], a[88:91], v[108:123]
  ds_read_b64_tr_b16 v[56:57], v15 offset:16384
  ds_read_b64_tr_b16 v[58:59], v15 offset:16896
  v_mul_f32 v97, v97, v105
  v_mul_f32 v98, v98, v106
  v_mul_f32 v99, v99, v107
  v_mfma_f32_32x32x16_bf16 v[124:139], v[64:67], a[88:91], v[124:139]
  ds_read_b64_tr_b16 v[60:61], v14 offset:20480
  ds_read_b64_tr_b16 v[62:63], v14 offset:20992
  v_fma_f32 v24, v24, v23, v23
  v_fma_f32 v25, v25, v23, v23
  v_fma_f32 v26, v26, v23, v23
  s_waitcnt lgkmcnt(6)
  v_mfma_f32_32x32x16_bf16 v[108:123], v[68:71], a[92:95], v[108:123]
  ds_read_b64_tr_b16 v[64:65], v15 offset:20480
  ds_read_b64_tr_b16 v[66:67], v15 offset:20992
  v_fma_f32 v27, v27, v23, v23
  v_fma_f32 v28, v28, v23, v23
  v_fma_f32 v29, v29, v23, v23
  v_mfma_f32_32x32x16_bf16 v[124:139], v[72:75], a[92:95], v[124:139]
  ds_read_b64_tr_b16 v[68:69], v14 offset:24576
  ds_read_b64_tr_b16 v[70:71], v14 offset:25088
  v_fma_f32 v30, v30, v23, v23
  v_fma_f32 v31, v31, v23, v23
  v_rcp_f32 v24, v24
  s_waitcnt lgkmcnt(6)
  v_mfma_f32_32x32x16_bf16 v[108:123], v[52:55], a[96:99], v[108:123]
  ds_read_b64_tr_b16 v[72:73], v15 offset:24576
  ds_read_b64_tr_b16 v[74:75], v15 offset:25088
  v_rcp_f32 v25, v25
  v_rcp_f32 v26, v26
  v_rcp_f32 v27, v27
  v_mfma_f32_32x32x16_bf16 v[124:139], v[56:59], a[96:99], v[124:139]
  ds_read_b64_tr_b16 v[52:53], v14 offset:28672
  ds_read_b64_tr_b16 v[54:55], v14 offset:29184
  v_rcp_f32 v28, v28
  v_rcp_f32 v29, v29
  v_rcp_f32 v30, v30
  s_waitcnt lgkmcnt(6)
  v_mfma_f32_32x32x16_bf16 v[108:123], v[60:63], a[100:103], v[108:123]
  ds_read_b64_tr_b16 v[56:57], v15 offset:28672
  ds_read_b64_tr_b16 v[58:59], v15 offset:29184
  v_rcp_f32 v31, v31
  v_mul_f32 v92, v92, v24
  v_mul_f32 v93, v93, v25
  v_mfma_f32_32x32x16_bf16 v[124:139], v[64:67], a[100:103], v[124:139]
  v_mul_f32 v94, v94, v26
  v_mul_f32 v95, v95, v27
  v_mul_f32 v96, v96, v28
  s_waitcnt lgkmcnt(4)
  v_mfma_f32_32x32x16_bf16 v[108:123], v[68:71], a[104:107], v[108:123]
  v_mul_f32 v97, v97, v29
  v_mul_f32 v98, v98, v30
  v_mul_f32 v99, v99, v31
  v_mfma_f32_32x32x16_bf16 v[124:139], v[72:75], a[104:107], v[124:139]
  v_cvt_pk_bf16_f32 v32, v92, v93
  v_cvt_pk_bf16_f32 v33, v94, v95
  v_cvt_pk_bf16_f32 v34, v96, v97
  s_waitcnt lgkmcnt(0)
  v_mfma_f32_32x32x16_bf16 v[108:123], v[52:55], a[108:111], v[108:123]
  v_cvt_pk_bf16_f32 v35, v98, v99
  s_nop 1
  v_permlane32_swap_b32 v32, v34
  v_mfma_f32_32x32x16_bf16 v[124:139], v[56:59], a[108:111], v[124:139]
  v_permlane32_swap_b32 v33, v35
  buffer_store_dwordx4 v[32:35], v2, s[24:27], s70 offen offset:1024 sc1
  s_nop 1
  s_barrier
  s_nop 15
  v_pk_fma_f32 v[108:109], v[36:37], v[20:21], v[108:109] op_sel:[0,1,0] op_sel_hi:[1,1,1]
  v_pk_fma_f32 v[110:111], v[38:39], v[20:21], v[110:111] op_sel:[0,1,0] op_sel_hi:[1,1,1]
  v_pk_fma_f32 v[112:113], v[40:41], v[20:21], v[112:113] op_sel:[0,1,0] op_sel_hi:[1,1,1]
  v_pk_fma_f32 v[114:115], v[42:43], v[20:21], v[114:115] op_sel:[0,1,0] op_sel_hi:[1,1,1]
  v_pk_fma_f32 v[116:117], v[44:45], v[20:21], v[116:117] op_sel:[0,1,0] op_sel_hi:[1,1,1]
  v_pk_fma_f32 v[118:119], v[46:47], v[20:21], v[118:119] op_sel:[0,1,0] op_sel_hi:[1,1,1]
  v_pk_fma_f32 v[120:121], v[48:49], v[20:21], v[120:121] op_sel:[0,1,0] op_sel_hi:[1,1,1]
  v_pk_fma_f32 v[122:123], v[50:51], v[20:21], v[122:123] op_sel:[0,1,0] op_sel_hi:[1,1,1]
  ds_read_b128 v[36:39], v20 offset:448
  ds_read_b128 v[40:43], v20 offset:480
  ds_read_b128 v[44:47], v20 offset:960
  ds_read_b128 v[48:51], v20 offset:992
  v_pk_mul_f32 v[24:25], v[108:109], v[22:23] op_sel_hi:[1,0]
  v_pk_mul_f32 v[26:27], v[110:111], v[22:23] op_sel_hi:[1,0]
  v_pk_mul_f32 v[28:29], v[112:113], v[22:23] op_sel_hi:[1,0]
  v_pk_mul_f32 v[30:31], v[114:115], v[22:23] op_sel_hi:[1,0]
  v_exp_f32 v24, v24
  v_exp_f32 v25, v25
  v_exp_f32 v26, v26
  v_exp_f32 v27, v27
  v_exp_f32 v28, v28
  v_exp_f32 v29, v29
  v_exp_f32 v30, v30
  v_exp_f32 v31, v31
  v_pk_mul_f32 v[108:109], v[108:109], v[116:117]
  v_pk_mul_f32 v[110:111], v[110:111], v[118:119]
  v_pk_mul_f32 v[112:113], v[112:113], v[120:121]
  v_pk_mul_f32 v[114:115], v[114:115], v[122:123]
  v_pk_fma_f32 v[24:25], v[24:25], v[22:23], v[22:23] op_sel:[0,1,1] op_sel_hi:[1,1,1]
  v_pk_fma_f32 v[26:27], v[26:27], v[22:23], v[22:23] op_sel:[0,1,1] op_sel_hi:[1,1,1]
  v_pk_fma_f32 v[28:29], v[28:29], v[22:23], v[22:23] op_sel:[0,1,1] op_sel_hi:[1,1,1]
  v_pk_fma_f32 v[30:31], v[30:31], v[22:23], v[22:23] op_sel:[0,1,1] op_sel_hi:[1,1,1]
  v_rcp_f32 v24, v24
  v_rcp_f32 v25, v25
  v_rcp_f32 v26, v26
  v_rcp_f32 v27, v27
  v_rcp_f32 v28, v28
  v_rcp_f32 v29, v29
  v_rcp_f32 v30, v30
  v_rcp_f32 v31, v31
  s_nop 0
  v_pk_mul_f32 v[108:109], v[108:109], v[24:25]
  v_pk_mul_f32 v[110:111], v[110:111], v[26:27]
  v_pk_mul_f32 v[112:113], v[112:113], v[28:29]
  v_pk_mul_f32 v[114:115], v[114:115], v[30:31]
  v_cvt_pk_bf16_f32 v32, v108, v109
  v_cvt_pk_bf16_f32 v33, v110, v111
  v_cvt_pk_bf16_f32 v34, v112, v113
  v_cvt_pk_bf16_f32 v35, v114, v115
  s_nop 1
  v_permlane32_swap_b32 v32, v34
  v_permlane32_swap_b32 v33, v35
  buffer_store_dwordx4 v[32:35], v2, s[24:27], s70 offen offset:2048 sc1
  s_nop 1
  s_waitcnt lgkmcnt(0)
  v_pk_fma_f32 v[124:125], v[36:37], v[20:21], v[124:125] op_sel:[0,1,0] op_sel_hi:[1,1,1]
  v_pk_fma_f32 v[126:127], v[38:39], v[20:21], v[126:127] op_sel:[0,1,0] op_sel_hi:[1,1,1]
  v_pk_fma_f32 v[128:129], v[40:41], v[20:21], v[128:129] op_sel:[0,1,0] op_sel_hi:[1,1,1]
  v_pk_fma_f32 v[130:131], v[42:43], v[20:21], v[130:131] op_sel:[0,1,0] op_sel_hi:[1,1,1]
  v_pk_fma_f32 v[132:133], v[44:45], v[20:21], v[132:133] op_sel:[0,1,0] op_sel_hi:[1,1,1]
  v_pk_fma_f32 v[134:135], v[46:47], v[20:21], v[134:135] op_sel:[0,1,0] op_sel_hi:[1,1,1]
  v_pk_fma_f32 v[136:137], v[48:49], v[20:21], v[136:137] op_sel:[0,1,0] op_sel_hi:[1,1,1]
  v_pk_fma_f32 v[138:139], v[50:51], v[20:21], v[138:139] op_sel:[0,1,0] op_sel_hi:[1,1,1]
  v_pk_mul_f32 v[24:25], v[124:125], v[22:23] op_sel_hi:[1,0]
  v_pk_mul_f32 v[26:27], v[126:127], v[22:23] op_sel_hi:[1,0]
  v_pk_mul_f32 v[28:29], v[128:129], v[22:23] op_sel_hi:[1,0]
  v_pk_mul_f32 v[30:31], v[130:131], v[22:23] op_sel_hi:[1,0]
  v_exp_f32 v24, v24
  v_exp_f32 v25, v25
  v_exp_f32 v26, v26
  v_exp_f32 v27, v27
  v_exp_f32 v28, v28
  v_exp_f32 v29, v29
  v_exp_f32 v30, v30
  v_exp_f32 v31, v31
  v_pk_mul_f32 v[124:125], v[124:125], v[132:133]
  v_pk_mul_f32 v[126:127], v[126:127], v[134:135]
  v_pk_mul_f32 v[128:129], v[128:129], v[136:137]
  v_pk_mul_f32 v[130:131], v[130:131], v[138:139]
  v_pk_fma_f32 v[24:25], v[24:25], v[22:23], v[22:23] op_sel:[0,1,1] op_sel_hi:[1,1,1]
  v_pk_fma_f32 v[26:27], v[26:27], v[22:23], v[22:23] op_sel:[0,1,1] op_sel_hi:[1,1,1]
  v_pk_fma_f32 v[28:29], v[28:29], v[22:23], v[22:23] op_sel:[0,1,1] op_sel_hi:[1,1,1]
  v_pk_fma_f32 v[30:31], v[30:31], v[22:23], v[22:23] op_sel:[0,1,1] op_sel_hi:[1,1,1]
  v_rcp_f32 v24, v24
  v_rcp_f32 v25, v25
  v_rcp_f32 v26, v26
  v_rcp_f32 v27, v27
  v_rcp_f32 v28, v28
  v_rcp_f32 v29, v29
  v_rcp_f32 v30, v30
  v_rcp_f32 v31, v31
  s_nop 0
  v_pk_mul_f32 v[124:125], v[124:125], v[24:25]
  v_pk_mul_f32 v[126:127], v[126:127], v[26:27]
  v_pk_mul_f32 v[128:129], v[128:129], v[28:29]
  v_pk_mul_f32 v[130:131], v[130:131], v[30:31]
  v_cvt_pk_bf16_f32 v32, v124, v125
  v_cvt_pk_bf16_f32 v33, v126, v127
  v_cvt_pk_bf16_f32 v34, v128, v129
  v_cvt_pk_bf16_f32 v35, v130, v131
  s_nop 1
  v_permlane32_swap_b32 v32, v34
  v_permlane32_swap_b32 v33, v35
  buffer_store_dwordx4 v[32:35], v2, s[24:27], s70 offen offset:3072 sc1
  s_nop 1
  s_barrier
  s_mul_i32 s56, s54, 9363
  s_lshr_b32 s56, s56, 16
  s_mul_i32 s57, s56, 7
  s_sub_u32 s60, s54, s57
  s_lshl_b32 s59, s53, 2
  s_add_u32 s59, s59, s56
  s_and_b32 s61, s52, 1
  s_lshr_b32 s62, s52, 1
  v_lshlrev_b32 v5, 4, v1
  v_lshrrev_b32 v6, 5, v1
  v_and_b32 v7, 31, v1
  s_lshl_b32 s56, s59, 6
  s_lshl_b32 s57, s62, 5
  s_add_u32 s65, s56, s57
  s_mul_i32 s56, s65, 896
  s_lshl_b32 s57, s60, 7
  s_add_u32 s56, s56, s57
  s_lshl_b32 s57, s61, 6
  s_add_u32 s64, s56, s57
  s_lshl_b32 s56, s59, 1
  s_add_u32 s56, s56, s62
  s_mul_i32 s56, s56, 28
  s_lshl_b32 s57, s60, 2
  s_add_u32 s56, s56, s57
  s_lshl_b32 s57, s61, 1
  s_add_u32 s56, s56, s57
  s_lshl_b32 s56, s56, 10
  s_add_u32 s63, s56, 0x200000
  s_lshl_b32 s56, s62, 12
  v_add_u32 v16, s56, v5
  v_and_b32 v2, 15, v1
  v_lshrrev_b32 v2, 2, v2
  v_lshlrev_b32 v3, 3, v6
  v_add_u32 v3, v3, v2
  v_lshlrev_b32 v19, 7, v3
  v_bfe_u32 v3, v1, 4, 1
  s_lshl_b32 s56, s61, 1
  v_add_u32 v3, s56, v3
  v_and_b32 v2, 2, v2
  v_xor_b32 v3, v3, v2
  v_lshlrev_b32 v3, 5, v3
  v_add_u32 v19, v19, v3
  v_and_b32 v2, 3, v1
  v_lshlrev_b32 v2, 3, v2
  v_add_u32 v19, v19, v2
  v_add_u32 v17, 0x10000, v16
  v_add_u32 v20, 0x10000, v19
  v_add_u32 v18, 0x20000, v16
  v_add_u32 v21, 0x20000, v19
  s_barrier
  ds_read_b128 v[44:47], v17 offset:0
  ds_read_b64_tr_b16 v[40:41], v19 offset:0
  ds_read_b64_tr_b16 v[42:43], v19 offset:512
  ds_read_b128 v[52:55], v17 offset:1024
  ds_read_b64_tr_b16 v[48:49], v19 offset:2048
  ds_read_b64_tr_b16 v[50:51], v19 offset:2560
  ds_read_b128 v[60:63], v17 offset:2048
  ds_read_b64_tr_b16 v[56:57], v19 offset:4096
  ds_read_b64_tr_b16 v[58:59], v19 offset:4608
  ds_read_b128 v[68:71], v17 offset:3072
  ds_read_b64_tr_b16 v[64:65], v19 offset:6144
  ds_read_b64_tr_b16 v[66:67], v19 offset:6656
  s_barrier
  s_waitcnt lgkmcnt(9)
  v_mfma_f32_32x32x16_bf16 v[24:39], v[40:43], v[44:47], 0
  ds_read_b128 v[76:79], v17 offset:8192
  ds_read_b64_tr_b16 v[72:73], v19 offset:8192
  ds_read_b64_tr_b16 v[74:75], v19 offset:8704
  s_waitcnt lgkmcnt(9)
  v_mfma_f32_32x32x16_bf16 v[24:39], v[48:51], v[52:55], v[24:39]
  ds_read_b128 v[84:87], v17 offset:9216
  ds_read_b64_tr_b16 v[80:81], v19 offset:10240
  ds_read_b64_tr_b16 v[82:83], v19 offset:10752
  s_waitcnt lgkmcnt(9)
  v_mfma_f32_32x32x16_bf16 v[24:39], v[56:59], v[60:63], v[24:39]
  ds_read_b128 v[92:95], v17 offset:10240
  ds_read_b64_tr_b16 v[88:89], v19 offset:12288
  ds_read_b64_tr_b16 v[90:91], v19 offset:12800
  s_waitcnt lgkmcnt(9)
  v_mfma_f32_32x32x16_bf16 v[24:39], v[64:67], v[68:71], v[24:39]
  ds_read_b128 v[100:103], v17 offset:11264
  ds_read_b64_tr_b16 v[96:97], v19 offset:14336
  ds_read_b64_tr_b16 v[98:99], v19 offset:14848
  s_waitcnt vmcnt(0)
  s_barrier
  s_cmp_lg_u32 s52, 0
  s_cbranch_scc1 Lpub_20
  s_add_u32 s56, s14, 0x8000
  buffer_store_dword v140, v141, s[24:27], s56 offen
  buffer_store_dword v140, v141, s[24:27], s14 offen sc0 sc1
Lpub_20:
  s_waitcnt lgkmcnt(9)
  v_mfma_f32_32x32x16_bf16 v[24:39], v[72:75], v[76:79], v[24:39]
  ds_read_b128 v[44:47], v17 offset:16384
  ds_read_b64_tr_b16 v[40:41], v19 offset:16384
  ds_read_b64_tr_b16 v[42:43], v19 offset:16896
  s_waitcnt lgkmcnt(9)
  v_mfma_f32_32x32x16_bf16 v[24:39], v[80:83], v[84:87], v[24:39]
  ds_read_b128 v[52:55], v17 offset:17408
  ds_read_b64_tr_b16 v[48:49], v19 offset:18432
  ds_read_b64_tr_b16 v[50:51], v19 offset:18944
  s_waitcnt lgkmcnt(9)
  v_mfma_f32_32x32x16_bf16 v[24:39], v[88:91], v[92:95], v[24:39]
  ds_read_b128 v[60:63], v17 offset:18432
  ds_read_b64_tr_b16 v[56:57], v19 offset:20480
  ds_read_b64_tr_b16 v[58:59], v19 offset:20992
  s_waitcnt lgkmcnt(9)
  v_mfma_f32_32x32x16_bf16 v[24:39], v[96:99], v[100:103], v[24:39]
  ds_read_b128 v[68:71], v17 offset:19456
  ds_read_b64_tr_b16 v[64:65], v19 offset:22528
  ds_read_b64_tr_b16 v[66:67], v19 offset:23040
  s_barrier
  v_lshlrev_b32 v2, 4, v7
  v_lshlrev_b32 v3, 3, v6
  v_add_u32 v2, v2, v3
  buffer_load_dwordx2 v[8:9], v2, s[24:27], s63 offen offset:0 sc1
  buffer_load_dwordx2 v[10:11], v2, s[24:27], s63 offen offset:512 sc1
  buffer_load_dwordx2 v[12:13], v2, s[24:27], s63 offen offset:1024 sc1
  buffer_load_dwordx2 v[14:15], v2, s[24:27], s63 offen offset:1536 sc1
  s_waitcnt lgkmcnt(9)
  v_mfma_f32_32x32x16_bf16 v[24:39], v[40:43], v[44:47], v[24:39]
  ds_read_b128 v[76:79], v17 offset:24576
  ds_read_b64_tr_b16 v[72:73], v19 offset:24576
  ds_read_b64_tr_b16 v[74:75], v19 offset:25088
  s_waitcnt lgkmcnt(9)
  v_mfma_f32_32x32x16_bf16 v[24:39], v[48:51], v[52:55], v[24:39]
  ds_read_b128 v[84:87], v17 offset:25600
  ds_read_b64_tr_b16 v[80:81], v19 offset:26624
  ds_read_b64_tr_b16 v[82:83], v19 offset:27136
  s_waitcnt lgkmcnt(9)
  v_mfma_f32_32x32x16_bf16 v[24:39], v[56:59], v[60:63], v[24:39]
  ds_read_b128 v[92:95], v17 offset:26624
  ds_read_b64_tr_b16 v[88:89], v19 offset:28672
  ds_read_b64_tr_b16 v[90:91], v19 offset:29184
  s_waitcnt lgkmcnt(9)
  v_mfma_f32_32x32x16_bf16 v[24:39], v[64:67], v[68:71], v[24:39]
  ds_read_b128 v[100:103], v17 offset:27648
  ds_read_b64_tr_b16 v[96:97], v19 offset:30720
  ds_read_b64_tr_b16 v[98:99], v19 offset:31232
  s_barrier
  s_waitcnt lgkmcnt(9)
  v_mfma_f32_32x32x16_bf16 v[24:39], v[72:75], v[76:79], v[24:39]
  ds_read_b128 v[44:47], v16 offset:57344
  ds_read_b64_tr_b16 v[40:41], v19 offset:32768
  ds_read_b64_tr_b16 v[42:43], v19 offset:33280
  s_waitcnt lgkmcnt(9)
  v_mfma_f32_32x32x16_bf16 v[24:39], v[80:83], v[84:87], v[24:39]
  ds_read_b128 v[52:55], v16 offset:58368
  ds_read_b64_tr_b16 v[48:49], v19 offset:34816
  ds_read_b64_tr_b16 v[50:51], v19 offset:35328
  s_waitcnt lgkmcnt(9)
  v_mfma_f32_32x32x16_bf16 v[24:39], v[88:91], v[92:95], v[24:39]
  ds_read_b128 v[60:63], v16 offset:59392
  ds_read_b64_tr_b16 v[56:57], v19 offset:36864
  ds_read_b64_tr_b16 v[58:59], v19 offset:37376
  s_waitcnt lgkmcnt(9)
  v_mfma_f32_32x32x16_bf16 v[24:39], v[96:99], v[100:103], v[24:39]
  ds_read_b128 v[68:71], v16 offset:60416
  ds_read_b64_tr_b16 v[64:65], v19 offset:38912
  ds_read_b64_tr_b16 v[66:67], v19 offset:39424
  s_barrier
  s_waitcnt lgkmcnt(9)
  v_mfma_f32_32x32x16_bf16 v[24:39], v[40:43], v[44:47], v[24:39]
  ds_read_b128 v[76:79], v18 offset:0
  ds_read_b64_tr_b16 v[72:73], v19 offset:40960
  ds_read_b64_tr_b16 v[74:75], v19 offset:41472
  s_waitcnt lgkmcnt(9)
  v_mfma_f32_32x32x16_bf16 v[24:39], v[48:51], v[52:55], v[24:39]
  ds_read_b128 v[84:87], v18 offset:1024
  ds_read_b64_tr_b16 v[80:81], v19 offset:43008
  ds_read_b64_tr_b16 v[82:83], v19 offset:43520
  s_waitcnt lgkmcnt(9)
  v_mfma_f32_32x32x16_bf16 v[24:39], v[56:59], v[60:63], v[24:39]
  ds_read_b128 v[92:95], v18 offset:2048
  ds_read_b64_tr_b16 v[88:89], v19 offset:45056
  ds_read_b64_tr_b16 v[90:91], v19 offset:45568
  s_waitcnt lgkmcnt(9)
  v_mfma_f32_32x32x16_bf16 v[24:39], v[64:67], v[68:71], v[24:39]
  ds_read_b128 v[100:103], v18 offset:3072
  ds_read_b64_tr_b16 v[96:97], v19 offset:47104
  ds_read_b64_tr_b16 v[98:99], v19 offset:47616
  s_barrier
  s_waitcnt lgkmcnt(9)
  v_mfma_f32_32x32x16_bf16 v[24:39], v[72:75], v[76:79], v[24:39]
  ds_read_b128 v[44:47], v18 offset:8192
  ds_read_b64_tr_b16 v[40:41], v19 offset:49152
  ds_read_b64_tr_b16 v[42:43], v19 offset:49664
  s_waitcnt lgkmcnt(9)
  v_mfma_f32_32x32x16_bf16 v[24:39], v[80:83], v[84:87], v[24:39]
  ds_read_b128 v[52:55], v18 offset:9216
  ds_read_b64_tr_b16 v[48:49], v19 offset:51200
  ds_read_b64_tr_b16 v[50:51], v19 offset:51712
  s_waitcnt lgkmcnt(9)
  v_mfma_f32_32x32x16_bf16 v[24:39], v[88:91], v[92:95], v[24:39]
  ds_read_b128 v[60:63], v18 offset:10240
  ds_read_b64_tr_b16 v[56:57], v19 offset:53248
  ds_read_b64_tr_b16 v[58:59], v19 offset:53760
  s_waitcnt lgkmcnt(9)
  v_mfma_f32_32x32x16_bf16 v[24:39], v[96:99], v[100:103], v[24:39]
  ds_read_b128 v[68:71], v18 offset:11264
  ds_read_b64_tr_b16 v[64:65], v19 offset:55296
  ds_read_b64_tr_b16 v[66:67], v19 offset:55808
  s_barrier
  s_waitcnt lgkmcnt(9)
  v_mfma_f32_32x32x16_bf16 v[24:39], v[40:43], v[44:47], v[24:39]
  ds_read_b128 v[76:79], v18 offset:16384
  ds_read_b64_tr_b16 v[72:73], v20 offset:32768
  ds_read_b64_tr_b16 v[74:75], v20 offset:33280
  s_waitcnt lgkmcnt(9)
  v_mfma_f32_32x32x16_bf16 v[24:39], v[48:51], v[52:55], v[24:39]
  ds_read_b128 v[84:87], v18 offset:17408
  ds_read_b64_tr_b16 v[80:81], v20 offset:34816
  ds_read_b64_tr_b16 v[82:83], v20 offset:35328
  s_waitcnt lgkmcnt(9)
  v_mfma_f32_32x32x16_bf16 v[24:39], v[56:59], v[60:63], v[24:39]
  ds_read_b128 v[92:95], v18 offset:18432
  ds_read_b64_tr_b16 v[88:89], v20 offset:36864
  ds_read_b64_tr_b16 v[90:91], v20 offset:37376
  s_waitcnt lgkmcnt(9)
  v_mfma_f32_32x32x16_bf16 v[24:39], v[64:67], v[68:71], v[24:39]
  ds_read_b128 v[100:103], v18 offset:19456
  ds_read_b64_tr_b16 v[96:97], v20 offset:38912
  ds_read_b64_tr_b16 v[98:99], v20 offset:39424
  s_barrier
  s_waitcnt lgkmcnt(9)
  v_mfma_f32_32x32x16_bf16 v[24:39], v[72:75], v[76:79], v[24:39]
  ds_read_b128 v[44:47], v18 offset:24576
  ds_read_b64_tr_b16 v[40:41], v20 offset:40960
  ds_read_b64_tr_b16 v[42:43], v20 offset:41472
  s_waitcnt lgkmcnt(9)
  v_mfma_f32_32x32x16_bf16 v[24:39], v[80:83], v[84:87], v[24:39]
  ds_read_b128 v[52:55], v18 offset:25600
  ds_read_b64_tr_b16 v[48:49], v20 offset:43008
  ds_read_b64_tr_b16 v[50:51], v20 offset:43520
  s_waitcnt lgkmcnt(9)
  v_mfma_f32_32x32x16_bf16 v[24:39], v[88:91], v[92:95], v[24:39]
  ds_read_b128 v[60:63], v18 offset:26624
  ds_read_b64_tr_b16 v[56:57], v20 offset:45056
  ds_read_b64_tr_b16 v[58:59], v20 offset:45568
  s_waitcnt lgkmcnt(9)
  v_mfma_f32_32x32x16_bf16 v[24:39], v[96:99], v[100:103], v[24:39]
  ds_read_b128 v[68:71], v18 offset:27648
  ds_read_b64_tr_b16 v[64:65], v20 offset:47104
  ds_read_b64_tr_b16 v[66:67], v20 offset:47616
  s_barrier
  s_waitcnt lgkmcnt(9)
  v_mfma_f32_32x32x16_bf16 v[24:39], v[40:43], v[44:47], v[24:39]
  ds_read_b128 v[76:79], v16 offset:0
  ds_read_b64_tr_b16 v[72:73], v20 offset:49152
  ds_read_b64_tr_b16 v[74:75], v20 offset:49664
  s_waitcnt lgkmcnt(9)
  v_mfma_f32_32x32x16_bf16 v[24:39], v[48:51], v[52:55], v[24:39]
  ds_read_b128 v[84:87], v16 offset:1024
  ds_read_b64_tr_b16 v[80:81], v20 offset:51200
  ds_read_b64_tr_b16 v[82:83], v20 offset:51712
  s_waitcnt lgkmcnt(9)
  v_mfma_f32_32x32x16_bf16 v[24:39], v[56:59], v[60:63], v[24:39]
  ds_read_b128 v[92:95], v16 offset:2048
  ds_read_b64_tr_b16 v[88:89], v20 offset:53248
  ds_read_b64_tr_b16 v[90:91], v20 offset:53760
  s_waitcnt lgkmcnt(9)
  v_mfma_f32_32x32x16_bf16 v[24:39], v[64:67], v[68:71], v[24:39]
  ds_read_b128 v[100:103], v16 offset:3072
  ds_read_b64_tr_b16 v[96:97], v20 offset:55296
  ds_read_b64_tr_b16 v[98:99], v20 offset:55808
  s_barrier
  s_waitcnt lgkmcnt(9)
  v_mfma_f32_32x32x16_bf16 v[24:39], v[72:75], v[76:79], v[24:39]
  ds_read_b128 v[44:47], v17 offset:0
  ds_read_b64_tr_b16 v[40:41], v20 offset:57344
  ds_read_b64_tr_b16 v[42:43], v20 offset:57856
  s_waitcnt lgkmcnt(9)
  v_mfma_f32_32x32x16_bf16 v[24:39], v[80:83], v[84:87], v[24:39]
  ds_read_b128 v[52:55], v17 offset:1024
  ds_read_b64_tr_b16 v[48:49], v20 offset:59392
  ds_read_b64_tr_b16 v[50:51], v20 offset:59904
  s_waitcnt lgkmcnt(9)
  v_mfma_f32_32x32x16_bf16 v[24:39], v[88:91], v[92:95], v[24:39]
  ds_read_b128 v[60:63], v17 offset:2048
  ds_read_b64_tr_b16 v[56:57], v20 offset:61440
  ds_read_b64_tr_b16 v[58:59], v20 offset:61952
  s_waitcnt lgkmcnt(9)
  v_mfma_f32_32x32x16_bf16 v[24:39], v[96:99], v[100:103], v[24:39]
  ds_read_b128 v[68:71], v17 offset:3072
  ds_read_b64_tr_b16 v[64:65], v20 offset:63488
  ds_read_b64_tr_b16 v[66:67], v20 offset:64000
  s_barrier
  s_waitcnt lgkmcnt(9)
  v_mfma_f32_32x32x16_bf16 v[24:39], v[40:43], v[44:47], v[24:39]
  ds_read_b128 v[76:79], v16 offset:8192
  ds_read_b64_tr_b16 v[72:73], v20 offset:8192
  ds_read_b64_tr_b16 v[74:75], v20 offset:8704
  s_waitcnt lgkmcnt(9)
  v_mfma_f32_32x32x16_bf16 v[24:39], v[48:51], v[52:55], v[24:39]
  ds_read_b128 v[84:87], v16 offset:9216
  ds_read_b64_tr_b16 v[80:81], v20 offset:10240
  ds_read_b64_tr_b16 v[82:83], v20 offset:10752
  s_waitcnt lgkmcnt(9)
  v_mfma_f32_32x32x16_bf16 v[24:39], v[56:59], v[60:63], v[24:39]
  ds_read_b128 v[92:95], v16 offset:10240
  ds_read_b64_tr_b16 v[88:89], v20 offset:12288
  ds_read_b64_tr_b16 v[90:91], v20 offset:12800
  s_waitcnt lgkmcnt(9)
  v_mfma_f32_32x32x16_bf16 v[24:39], v[64:67], v[68:71], v[24:39]
  ds_read_b128 v[100:103], v16 offset:11264
  ds_read_b64_tr_b16 v[96:97], v20 offset:14336
  ds_read_b64_tr_b16 v[98:99], v20 offset:14848
  s_barrier
  s_waitcnt lgkmcnt(9)
  v_mfma_f32_32x32x16_bf16 v[24:39], v[72:75], v[76:79], v[24:39]
  ds_read_b128 v[44:47], v16 offset:16384
  ds_read_b64_tr_b16 v[40:41], v20 offset:16384
  ds_read_b64_tr_b16 v[42:43], v20 offset:16896
  s_waitcnt lgkmcnt(9)
  v_mfma_f32_32x32x16_bf16 v[24:39], v[80:83], v[84:87], v[24:39]
  ds_read_b128 v[52:55], v16 offset:17408
  ds_read_b64_tr_b16 v[48:49], v20 offset:18432
  ds_read_b64_tr_b16 v[50:51], v20 offset:18944
  s_waitcnt lgkmcnt(9)
  v_mfma_f32_32x32x16_bf16 v[24:39], v[88:91], v[92:95], v[24:39]
  ds_read_b128 v[60:63], v16 offset:18432
  ds_read_b64_tr_b16 v[56:57], v20 offset:20480
  ds_read_b64_tr_b16 v[58:59], v20 offset:20992
  s_waitcnt lgkmcnt(9)
  v_mfma_f32_32x32x16_bf16 v[24:39], v[96:99], v[100:103], v[24:39]
  ds_read_b128 v[68:71], v16 offset:19456
  ds_read_b64_tr_b16 v[64:65], v20 offset:22528
  ds_read_b64_tr_b16 v[66:67], v20 offset:23040
  s_barrier
  s_waitcnt lgkmcnt(9)
  v_mfma_f32_32x32x16_bf16 v[24:39], v[40:43], v[44:47], v[24:39]
  ds_read_b128 v[76:79], v16 offset:24576
  ds_read_b64_tr_b16 v[72:73], v20 offset:24576
  ds_read_b64_tr_b16 v[74:75], v20 offset:25088
  s_waitcnt lgkmcnt(9)
  v_mfma_f32_32x32x16_bf16 v[24:39], v[48:51], v[52:55], v[24:39]
  ds_read_b128 v[84:87], v16 offset:25600
  ds_read_b64_tr_b16 v[80:81], v20 offset:26624
  ds_read_b64_tr_b16 v[82:83], v20 offset:27136
  s_waitcnt lgkmcnt(9)
  v_mfma_f32_32x32x16_bf16 v[24:39], v[56:59], v[60:63], v[24:39]
  ds_read_b128 v[92:95], v16 offset:26624
  ds_read_b64_tr_b16 v[88:89], v20 offset:28672
  ds_read_b64_tr_b16 v[90:91], v20 offset:29184
  s_waitcnt lgkmcnt(9)
  v_mfma_f32_32x32x16_bf16 v[24:39], v[64:67], v[68:71], v[24:39]
  ds_read_b128 v[100:103], v16 offset:27648
  ds_read_b64_tr_b16 v[96:97], v20 offset:30720
  ds_read_b64_tr_b16 v[98:99], v20 offset:31232
  s_barrier
  s_waitcnt lgkmcnt(9)
  v_mfma_f32_32x32x16_bf16 v[24:39], v[72:75], v[76:79], v[24:39]
  ds_read_b128 v[44:47], v18 offset:0
  ds_read_b64_tr_b16 v[40:41], v19 offset:32768
  ds_read_b64_tr_b16 v[42:43], v19 offset:33280
  s_waitcnt lgkmcnt(9)
  v_mfma_f32_32x32x16_bf16 v[24:39], v[80:83], v[84:87], v[24:39]
  ds_read_b128 v[52:55], v18 offset:1024
  ds_read_b64_tr_b16 v[48:49], v19 offset:34816
  ds_read_b64_tr_b16 v[50:51], v19 offset:35328
  s_waitcnt lgkmcnt(9)
  v_mfma_f32_32x32x16_bf16 v[24:39], v[88:91], v[92:95], v[24:39]
  ds_read_b128 v[60:63], v18 offset:2048
  ds_read_b64_tr_b16 v[56:57], v19 offset:36864
  ds_read_b64_tr_b16 v[58:59], v19 offset:37376
  s_waitcnt lgkmcnt(9)
  v_mfma_f32_32x32x16_bf16 v[24:39], v[96:99], v[100:103], v[24:39]
  ds_read_b128 v[68:71], v18 offset:3072
  ds_read_b64_tr_b16 v[64:65], v19 offset:38912
  ds_read_b64_tr_b16 v[66:67], v19 offset:39424
  s_barrier
  s_waitcnt lgkmcnt(9)
  v_mfma_f32_32x32x16_bf16 v[24:39], v[40:43], v[44:47], v[24:39]
  ds_read_b128 v[76:79], v16 offset:49152
  ds_read_b64_tr_b16 v[72:73], v19 offset:57344
  ds_read_b64_tr_b16 v[74:75], v19 offset:57856
  s_waitcnt lgkmcnt(9)
  v_mfma_f32_32x32x16_bf16 v[24:39], v[48:51], v[52:55], v[24:39]
  ds_read_b128 v[84:87], v16 offset:50176
  ds_read_b64_tr_b16 v[80:81], v19 offset:59392
  ds_read_b64_tr_b16 v[82:83], v19 offset:59904
  s_waitcnt lgkmcnt(9)
  v_mfma_f32_32x32x16_bf16 v[24:39], v[56:59], v[60:63], v[24:39]
  ds_read_b128 v[92:95], v16 offset:51200
  ds_read_b64_tr_b16 v[88:89], v19 offset:61440
  ds_read_b64_tr_b16 v[90:91], v19 offset:61952
  s_waitcnt lgkmcnt(9)
  v_mfma_f32_32x32x16_bf16 v[24:39], v[64:67], v[68:71], v[24:39]
  ds_read_b128 v[100:103], v16 offset:52224
  ds_read_b64_tr_b16 v[96:97], v19 offset:63488
  ds_read_b64_tr_b16 v[98:99], v19 offset:64000
  s_barrier
  s_waitcnt lgkmcnt(9)
  v_mfma_f32_32x32x16_bf16 v[24:39], v[72:75], v[76:79], v[24:39]
  ds_read_b128 v[44:47], v18 offset:8192
  ds_read_b64_tr_b16 v[40:41], v19 offset:40960
  ds_read_b64_tr_b16 v[42:43], v19 offset:41472
  s_waitcnt lgkmcnt(9)
  v_mfma_f32_32x32x16_bf16 v[24:39], v[80:83], v[84:87], v[24:39]
  ds_read_b128 v[52:55], v18 offset:9216
  ds_read_b64_tr_b16 v[48:49], v19 offset:43008
  ds_read_b64_tr_b16 v[50:51], v19 offset:43520
  s_waitcnt lgkmcnt(9)
  v_mfma_f32_32x32x16_bf16 v[24:39], v[88:91], v[92:95], v[24:39]
  ds_read_b128 v[60:63], v18 offset:10240
  ds_read_b64_tr_b16 v[56:57], v19 offset:45056
  ds_read_b64_tr_b16 v[58:59], v19 offset:45568
  s_waitcnt lgkmcnt(9)
  v_mfma_f32_32x32x16_bf16 v[24:39], v[96:99], v[100:103], v[24:39]
  ds_read_b128 v[68:71], v18 offset:11264
  ds_read_b64_tr_b16 v[64:65], v19 offset:47104
  ds_read_b64_tr_b16 v[66:67], v19 offset:47616
  s_barrier
  s_waitcnt lgkmcnt(9)
  v_mfma_f32_32x32x16_bf16 v[24:39], v[40:43], v[44:47], v[24:39]
  ds_read_b128 v[76:79], v17 offset:32768
  ds_read_b64_tr_b16 v[72:73], v21 offset:16384
  ds_read_b64_tr_b16 v[74:75], v21 offset:16896
  s_waitcnt lgkmcnt(9)
  v_mfma_f32_32x32x16_bf16 v[24:39], v[48:51], v[52:55], v[24:39]
  ds_read_b128 v[84:87], v17 offset:33792
  ds_read_b64_tr_b16 v[80:81], v21 offset:18432
  ds_read_b64_tr_b16 v[82:83], v21 offset:18944
  s_waitcnt lgkmcnt(9)
  v_mfma_f32_32x32x16_bf16 v[24:39], v[56:59], v[60:63], v[24:39]
  ds_read_b128 v[92:95], v17 offset:34816
  ds_read_b64_tr_b16 v[88:89], v21 offset:20480
  ds_read_b64_tr_b16 v[90:91], v21 offset:20992
  s_waitcnt lgkmcnt(9)
  v_mfma_f32_32x32x16_bf16 v[24:39], v[64:67], v[68:71], v[24:39]
  ds_read_b128 v[100:103], v17 offset:35840
  ds_read_b64_tr_b16 v[96:97], v21 offset:22528
  ds_read_b64_tr_b16 v[98:99], v21 offset:23040
  s_barrier
  s_waitcnt lgkmcnt(9)
  v_mfma_f32_32x32x16_bf16 v[24:39], v[72:75], v[76:79], v[24:39]
  ds_read_b128 v[44:47], v17 offset:40960
  ds_read_b64_tr_b16 v[40:41], v21 offset:24576
  ds_read_b64_tr_b16 v[42:43], v21 offset:25088
  s_waitcnt lgkmcnt(9)
  v_mfma_f32_32x32x16_bf16 v[24:39], v[80:83], v[84:87], v[24:39]
  ds_read_b128 v[52:55], v17 offset:41984
  ds_read_b64_tr_b16 v[48:49], v21 offset:26624
  ds_read_b64_tr_b16 v[50:51], v21 offset:27136
  s_waitcnt lgkmcnt(9)
  v_mfma_f32_32x32x16_bf16 v[24:39], v[88:91], v[92:95], v[24:39]
  ds_read_b128 v[60:63], v17 offset:43008
  ds_read_b64_tr_b16 v[56:57], v21 offset:28672
  ds_read_b64_tr_b16 v[58:59], v21 offset:29184
  s_waitcnt lgkmcnt(9)
  v_mfma_f32_32x32x16_bf16 v[24:39], v[96:99], v[100:103], v[24:39]
  ds_read_b128 v[68:71], v17 offset:44032
  ds_read_b64_tr_b16 v[64:65], v21 offset:30720
  ds_read_b64_tr_b16 v[66:67], v21 offset:31232
  s_barrier
  s_waitcnt lgkmcnt(9)
  v_mfma_f32_32x32x16_bf16 v[24:39], v[40:43], v[44:47], v[24:39]
  ds_read_b128 v[76:79], v17 offset:49152
  ds_read_b64_tr_b16 v[72:73], v19 offset:0
  ds_read_b64_tr_b16 v[74:75], v19 offset:512
  s_waitcnt lgkmcnt(9)
  v_mfma_f32_32x32x16_bf16 v[24:39], v[48:51], v[52:55], v[24:39]
  ds_read_b128 v[84:87], v17 offset:50176
  ds_read_b64_tr_b16 v[80:81], v19 offset:2048
  ds_read_b64_tr_b16 v[82:83], v19 offset:2560
  s_waitcnt lgkmcnt(9)
  v_mfma_f32_32x32x16_bf16 v[24:39], v[56:59], v[60:63], v[24:39]
  ds_read_b128 v[92:95], v17 offset:51200
  ds_read_b64_tr_b16 v[88:89], v19 offset:4096
  ds_read_b64_tr_b16 v[90:91], v19 offset:4608
  s_waitcnt lgkmcnt(9)
  v_mfma_f32_32x32x16_bf16 v[24:39], v[64:67], v[68:71], v[24:39]
  ds_read_b128 v[100:103], v17 offset:52224
  ds_read_b64_tr_b16 v[96:97], v19 offset:6144
  ds_read_b64_tr_b16 v[98:99], v19 offset:6656
  s_barrier
  s_waitcnt lgkmcnt(9)
  v_mfma_f32_32x32x16_bf16 v[24:39], v[72:75], v[76:79], v[24:39]
  ds_read_b128 v[44:47], v17 offset:57344
  ds_read_b64_tr_b16 v[40:41], v20 offset:0
  ds_read_b64_tr_b16 v[42:43], v20 offset:512
  s_waitcnt lgkmcnt(9)
  v_mfma_f32_32x32x16_bf16 v[24:39], v[80:83], v[84:87], v[24:39]
  ds_read_b128 v[52:55], v17 offset:58368
  ds_read_b64_tr_b16 v[48:49], v20 offset:2048
  ds_read_b64_tr_b16 v[50:51], v20 offset:2560
  s_waitcnt lgkmcnt(9)
  v_mfma_f32_32x32x16_bf16 v[24:39], v[88:91], v[92:95], v[24:39]
  ds_read_b128 v[60:63], v17 offset:59392
  ds_read_b64_tr_b16 v[56:57], v20 offset:4096
  ds_read_b64_tr_b16 v[58:59], v20 offset:4608
  s_waitcnt lgkmcnt(9)
  v_mfma_f32_32x32x16_bf16 v[24:39], v[96:99], v[100:103], v[24:39]
  ds_read_b128 v[68:71], v17 offset:60416
  ds_read_b64_tr_b16 v[64:65], v20 offset:6144
  ds_read_b64_tr_b16 v[66:67], v20 offset:6656
  s_barrier
  s_waitcnt vmcnt(0)
  v_lshlrev_b32 v120, 16, v8
  v_and_b32 v121, 0xffff0000, v8
  v_lshlrev_b32 v122, 16, v9
  v_and_b32 v123, 0xffff0000, v9
  v_lshlrev_b32 v124, 16, v10
  v_and_b32 v125, 0xffff0000, v10
  v_lshlrev_b32 v126, 16, v11
  v_and_b32 v127, 0xffff0000, v11
  v_lshlrev_b32 v128, 16, v12
  v_and_b32 v129, 0xffff0000, v12
  v_lshlrev_b32 v130, 16, v13
  v_and_b32 v131, 0xffff0000, v13
  v_lshlrev_b32 v132, 16, v14
  v_and_b32 v133, 0xffff0000, v14
  v_lshlrev_b32 v134, 16, v15
  v_and_b32 v135, 0xffff0000, v15
  s_waitcnt lgkmcnt(9)
  v_mfma_f32_32x32x16_bf16 v[24:39], v[40:43], v[44:47], v[24:39]
  ds_read_b128 v[76:79], v17 offset:8192
  ds_read_b64_tr_b16 v[72:73], v19 offset:8192
  ds_read_b64_tr_b16 v[74:75], v19 offset:8704
  s_waitcnt lgkmcnt(9)
  v_mfma_f32_32x32x16_bf16 v[24:39], v[48:51], v[52:55], v[24:39]
  ds_read_b128 v[84:87], v17 offset:9216
  ds_read_b64_tr_b16 v[80:81], v19 offset:10240
  ds_read_b64_tr_b16 v[82:83], v19 offset:10752
  s_waitcnt lgkmcnt(9)
  v_mfma_f32_32x32x16_bf16 v[24:39], v[56:59], v[60:63], v[24:39]
  ds_read_b128 v[92:95], v17 offset:10240
  ds_read_b64_tr_b16 v[88:89], v19 offset:12288
  ds_read_b64_tr_b16 v[90:91], v19 offset:12800
  s_waitcnt lgkmcnt(9)
  v_mfma_f32_32x32x16_bf16 v[24:39], v[64:67], v[68:71], v[24:39]
  ds_read_b128 v[100:103], v17 offset:11264
  ds_read_b64_tr_b16 v[96:97], v19 offset:14336
  ds_read_b64_tr_b16 v[98:99], v19 offset:14848
  s_barrier
  s_waitcnt lgkmcnt(9)
  v_mfma_f32_32x32x16_bf16 v[24:39], v[72:75], v[76:79], v[24:39]
  ds_read_b128 v[44:47], v17 offset:16384
  ds_read_b64_tr_b16 v[40:41], v19 offset:16384
  ds_read_b64_tr_b16 v[42:43], v19 offset:16896
  s_waitcnt lgkmcnt(9)
  v_mfma_f32_32x32x16_bf16 v[24:39], v[80:83], v[84:87], v[24:39]
  ds_read_b128 v[52:55], v17 offset:17408
  ds_read_b64_tr_b16 v[48:49], v19 offset:18432
  ds_read_b64_tr_b16 v[50:51], v19 offset:18944
  s_waitcnt lgkmcnt(9)
  v_mfma_f32_32x32x16_bf16 v[24:39], v[88:91], v[92:95], v[24:39]
  ds_read_b128 v[60:63], v17 offset:18432
  ds_read_b64_tr_b16 v[56:57], v19 offset:20480
  ds_read_b64_tr_b16 v[58:59], v19 offset:20992
  s_waitcnt lgkmcnt(9)
  v_mfma_f32_32x32x16_bf16 v[24:39], v[96:99], v[100:103], v[24:39]
  ds_read_b128 v[68:71], v17 offset:19456
  ds_read_b64_tr_b16 v[64:65], v19 offset:22528
  ds_read_b64_tr_b16 v[66:67], v19 offset:23040
  s_barrier
  s_waitcnt lgkmcnt(9)
  v_mfma_f32_32x32x16_bf16 v[24:39], v[40:43], v[44:47], v[24:39]
  ds_read_b128 v[76:79], v17 offset:24576
  ds_read_b64_tr_b16 v[72:73], v19 offset:24576
  ds_read_b64_tr_b16 v[74:75], v19 offset:25088
  s_waitcnt lgkmcnt(9)
  v_mfma_f32_32x32x16_bf16 v[24:39], v[48:51], v[52:55], v[24:39]
  ds_read_b128 v[84:87], v17 offset:25600
  ds_read_b64_tr_b16 v[80:81], v19 offset:26624
  ds_read_b64_tr_b16 v[82:83], v19 offset:27136
  s_waitcnt lgkmcnt(9)
  v_mfma_f32_32x32x16_bf16 v[24:39], v[56:59], v[60:63], v[24:39]
  ds_read_b128 v[92:95], v17 offset:26624
  ds_read_b64_tr_b16 v[88:89], v19 offset:28672
  ds_read_b64_tr_b16 v[90:91], v19 offset:29184
  s_waitcnt lgkmcnt(9)
  v_mfma_f32_32x32x16_bf16 v[24:39], v[64:67], v[68:71], v[24:39]
  ds_read_b128 v[100:103], v17 offset:27648
  ds_read_b64_tr_b16 v[96:97], v19 offset:30720
  ds_read_b64_tr_b16 v[98:99], v19 offset:31232
  s_barrier
  s_waitcnt lgkmcnt(9)
  v_mfma_f32_32x32x16_bf16 v[24:39], v[72:75], v[76:79], v[24:39]
  ds_read_b128 v[44:47], v16 offset:32768
  ds_read_b64_tr_b16 v[40:41], v21 offset:0
  ds_read_b64_tr_b16 v[42:43], v21 offset:512
  s_waitcnt lgkmcnt(9)
  v_mfma_f32_32x32x16_bf16 v[24:39], v[80:83], v[84:87], v[24:39]
  ds_read_b128 v[52:55], v16 offset:33792
  ds_read_b64_tr_b16 v[48:49], v21 offset:2048
  ds_read_b64_tr_b16 v[50:51], v21 offset:2560
  s_waitcnt lgkmcnt(9)
  v_mfma_f32_32x32x16_bf16 v[24:39], v[88:91], v[92:95], v[24:39]
  ds_read_b128 v[60:63], v16 offset:34816
  ds_read_b64_tr_b16 v[56:57], v21 offset:4096
  ds_read_b64_tr_b16 v[58:59], v21 offset:4608
  s_waitcnt lgkmcnt(9)
  v_mfma_f32_32x32x16_bf16 v[24:39], v[96:99], v[100:103], v[24:39]
  ds_read_b128 v[68:71], v16 offset:35840
  ds_read_b64_tr_b16 v[64:65], v21 offset:6144
  ds_read_b64_tr_b16 v[66:67], v21 offset:6656
  s_barrier
  s_waitcnt lgkmcnt(9)
  v_mfma_f32_32x32x16_bf16 v[24:39], v[40:43], v[44:47], v[24:39]
  ds_read_b128 v[76:79], v16 offset:57344
  ds_read_b64_tr_b16 v[72:73], v19 offset:49152
  ds_read_b64_tr_b16 v[74:75], v19 offset:49664
  s_waitcnt lgkmcnt(9)
  v_mfma_f32_32x32x16_bf16 v[24:39], v[48:51], v[52:55], v[24:39]
  ds_read_b128 v[84:87], v16 offset:58368
  ds_read_b64_tr_b16 v[80:81], v19 offset:51200
  ds_read_b64_tr_b16 v[82:83], v19 offset:51712
  s_waitcnt lgkmcnt(9)
  v_mfma_f32_32x32x16_bf16 v[24:39], v[56:59], v[60:63], v[24:39]
  ds_read_b128 v[92:95], v16 offset:59392
  ds_read_b64_tr_b16 v[88:89], v19 offset:53248
  ds_read_b64_tr_b16 v[90:91], v19 offset:53760
  s_waitcnt lgkmcnt(9)
  v_mfma_f32_32x32x16_bf16 v[24:39], v[64:67], v[68:71], v[24:39]
  ds_read_b128 v[100:103], v16 offset:60416
  ds_read_b64_tr_b16 v[96:97], v19 offset:55296
  ds_read_b64_tr_b16 v[98:99], v19 offset:55808
  s_barrier
  s_waitcnt lgkmcnt(9)
  v_mfma_f32_32x32x16_bf16 v[24:39], v[72:75], v[76:79], v[24:39]
  ds_read_b128 v[44:47], v16 offset:40960
  ds_read_b64_tr_b16 v[40:41], v21 offset:8192
  ds_read_b64_tr_b16 v[42:43], v21 offset:8704
  s_waitcnt lgkmcnt(9)
  v_mfma_f32_32x32x16_bf16 v[24:39], v[80:83], v[84:87], v[24:39]
  ds_read_b128 v[52:55], v16 offset:41984
  ds_read_b64_tr_b16 v[48:49], v21 offset:10240
  ds_read_b64_tr_b16 v[50:51], v21 offset:10752
  s_waitcnt lgkmcnt(9)
  v_mfma_f32_32x32x16_bf16 v[24:39], v[88:91], v[92:95], v[24:39]
  ds_read_b128 v[60:63], v16 offset:43008
  ds_read_b64_tr_b16 v[56:57], v21 offset:12288
  ds_read_b64_tr_b16 v[58:59], v21 offset:12800
  s_waitcnt lgkmcnt(9)
  v_mfma_f32_32x32x16_bf16 v[24:39], v[96:99], v[100:103], v[24:39]
  ds_read_b128 v[68:71], v16 offset:44032
  ds_read_b64_tr_b16 v[64:65], v21 offset:14336
  ds_read_b64_tr_b16 v[66:67], v21 offset:14848
  s_barrier
  s_waitcnt lgkmcnt(9)
  v_mfma_f32_32x32x16_bf16 v[24:39], v[40:43], v[44:47], v[24:39]
  ds_read_b128 v[76:79], v18 offset:16384
  ds_read_b64_tr_b16 v[72:73], v20 offset:32768
  ds_read_b64_tr_b16 v[74:75], v20 offset:33280
  s_waitcnt lgkmcnt(9)
  v_mfma_f32_32x32x16_bf16 v[24:39], v[48:51], v[52:55], v[24:39]
  ds_read_b128 v[84:87], v18 offset:17408
  ds_read_b64_tr_b16 v[80:81], v20 offset:34816
  ds_read_b64_tr_b16 v[82:83], v20 offset:35328
  s_waitcnt lgkmcnt(9)
  v_mfma_f32_32x32x16_bf16 v[24:39], v[56:59], v[60:63], v[24:39]
  ds_read_b128 v[92:95], v18 offset:18432
  ds_read_b64_tr_b16 v[88:89], v20 offset:36864
  ds_read_b64_tr_b16 v[90:91], v20 offset:37376
  s_waitcnt lgkmcnt(9)
  v_mfma_f32_32x32x16_bf16 v[24:39], v[64:67], v[68:71], v[24:39]
  ds_read_b128 v[100:103], v18 offset:19456
  ds_read_b64_tr_b16 v[96:97], v20 offset:38912
  ds_read_b64_tr_b16 v[98:99], v20 offset:39424
  s_waitcnt lgkmcnt(9)
  v_mfma_f32_32x32x16_bf16 v[24:39], v[72:75], v[76:79], v[24:39]
  s_waitcnt lgkmcnt(6)
  v_mfma_f32_32x32x16_bf16 v[24:39], v[80:83], v[84:87], v[24:39]
  s_waitcnt lgkmcnt(3)
  v_mfma_f32_32x32x16_bf16 v[24:39], v[88:91], v[92:95], v[24:39]
  s_waitcnt lgkmcnt(0)
  v_mfma_f32_32x32x16_bf16 v[24:39], v[96:99], v[100:103], v[24:39]
  s_nop 15
  v_pk_add_f32 v[24:25], v[24:25], v[120:121]
  v_pk_add_f32 v[26:27], v[26:27], v[122:123]
  v_pk_add_f32 v[28:29], v[28:29], v[124:125]
  v_pk_add_f32 v[30:31], v[30:31], v[126:127]
  v_pk_add_f32 v[32:33], v[32:33], v[128:129]
  v_pk_add_f32 v[34:35], v[34:35], v[130:131]
  v_pk_add_f32 v[36:37], v[36:37], v[132:133]
  v_pk_add_f32 v[38:39], v[38:39], v[134:135]
  v_cvt_pk_bf16_f32 v104, v24, v25
  v_cvt_pk_bf16_f32 v105, v26, v27
  v_cvt_pk_bf16_f32 v106, v28, v29
  v_cvt_pk_bf16_f32 v107, v30, v31
  v_cvt_pk_bf16_f32 v108, v32, v33
  v_cvt_pk_bf16_f32 v109, v34, v35
  v_cvt_pk_bf16_f32 v110, v36, v37
  v_cvt_pk_bf16_f32 v111, v38, v39
  s_nop 1
  v_permlane32_swap_b32 v104, v106
  v_permlane32_swap_b32 v105, v107
  v_permlane32_swap_b32 v108, v110
  v_permlane32_swap_b32 v109, v111
  v_mul_u32_u24 v2, 896, v7
  v_lshlrev_b32 v3, 4, v6
  v_add_u32 v2, v2, v3
  buffer_store_dwordx4 v[104:107], v2, s[48:51], s64 offen offset:0
  buffer_store_dwordx4 v[108:111], v2, s[48:51], s64 offen offset:32
  s_branch Lend
Lc_job:
  s_lshl_b32 s59, s53, 2
  s_add_u32 s59, s59, s54
  s_sub_u32 s59, s59, 28
  s_cmp_ge_u32 s59, 28
  s_cbranch_scc1 Lend
  s_cmp_lt_u32 s59, 14
  s_cselect_b32 s60, s8, s10
  s_cselect_b32 s61, s9, s11
  s_cselect_b32 s57, 0, 14
  s_mov_b32 s62, 0x188000
  s_mov_b32 s63, 0x20000
  s_sub_u32 s64, s59, s57
  v_lshrrev_b32 v2, 4, v1
  v_mul_u32_u24 v4, 3584, v2
  v_and_b32 v3, 15, v1
  v_lshlrev_b32 v5, 4, v3
  v_add_u32 v4, v4, v5
  s_lshl_b32 s56, s64, 8
  s_mul_i32 s57, s52, 14336
  s_add_u32 s56, s56, s57
  buffer_load_dwordx4 v[16:19], v4, s[60:63], s56 offen
  s_add_u32 s56, s56, 57344
  buffer_load_dwordx4 v[20:23], v4, s[60:63], s56 offen
  s_add_u32 s56, s56, 57344
  buffer_load_dwordx4 v[24:27], v4, s[60:63], s56 offen
  s_add_u32 s56, s56, 57344
  buffer_load_dwordx4 v[28:31], v4, s[60:63], s56 offen
  s_add_u32 s56, s56, 57344
  buffer_load_dwordx4 v[32:35], v4, s[60:63], s56 offen
  s_add_u32 s56, s56, 57344
  buffer_load_dwordx4 v[36:39], v4, s[60:63], s56 offen
  s_add_u32 s56, s56, 57344
  buffer_load_dwordx4 v[40:43], v4, s[60:63], s56 offen
  s_add_u32 s56, s56, 57344
  buffer_load_dwordx4 v[44:47], v4, s[60:63], s56 offen
  s_add_u32 s56, s56, 57344
  buffer_load_dwordx4 v[48:51], v4, s[60:63], s56 offen
  s_add_u32 s56, s56, 57344
  buffer_load_dwordx4 v[52:55], v4, s[60:63], s56 offen
  s_add_u32 s56, s56, 57344
  buffer_load_dwordx4 v[56:59], v4, s[60:63], s56 offen
  s_add_u32 s56, s56, 57344
  buffer_load_dwordx4 v[60:63], v4, s[60:63], s56 offen
  s_add_u32 s56, s56, 57344
  buffer_load_dwordx4 v[64:67], v4, s[60:63], s56 offen
  s_add_u32 s56, s56, 57344
  buffer_load_dwordx4 v[68:71], v4, s[60:63], s56 offen
  s_add_u32 s56, s56, 57344
  buffer_load_dwordx4 v[72:75], v4, s[60:63], s56 offen
  s_add_u32 s56, s56, 57344
  buffer_load_dwordx4 v[76:79], v4, s[60:63], s56 offen
  s_add_u32 s56, s56, 57344
  buffer_load_dwordx4 v[80:83], v4, s[60:63], s56 offen
  s_add_u32 s56, s56, 57344
  buffer_load_dwordx4 v[84:87], v4, s[60:63], s56 offen
  s_add_u32 s56, s56, 57344
  buffer_load_dwordx4 v[88:91], v4, s[60:63], s56 offen
  s_add_u32 s56, s56, 57344
  buffer_load_dwordx4 v[92:95], v4, s[60:63], s56 offen
  s_add_u32 s56, s56, 57344
  buffer_load_dwordx4 v[96:99], v4, s[60:63], s56 offen
  s_add_u32 s56, s56, 57344
  buffer_load_dwordx4 v[100:103], v4, s[60:63], s56 offen
  s_add_u32 s56, s56, 57344
  buffer_load_dwordx4 v[104:107], v4, s[60:63], s56 offen
  s_add_u32 s56, s56, 57344
  buffer_load_dwordx4 v[108:111], v4, s[60:63], s56 offen
  s_add_u32 s56, s56, 57344
  buffer_load_dwordx4 v[112:115], v4, s[60:63], s56 offen
  s_add_u32 s56, s56, 57344
  buffer_load_dwordx4 v[116:119], v4, s[60:63], s56 offen
  s_add_u32 s56, s56, 57344
  buffer_load_dwordx4 v[120:123], v4, s[60:63], s56 offen
  s_add_u32 s56, s56, 57344
  buffer_load_dwordx4 v[124:127], v4, s[60:63], s56 offen
  s_add_u32 s56, s56, 57344
  v_mov_b32 v6, 0x00003f80
  v_mov_b32 v7, 0x3f800000
  v_mov_b32 v8, 0
  v_mov_b32 v9, 0
  v_mov_b32 v10, 0
  v_mov_b32 v11, 0
  v_mov_b32 v12, 0
  v_mov_b32 v13, 0
  v_mov_b32 v14, 0
  v_mov_b32 v15, 0
  s_waitcnt vmcnt(27)
  v_dot2c_f32_bf16 v8, v16, v6
  v_dot2c_f32_bf16 v9, v16, v7
  v_dot2c_f32_bf16 v10, v17, v6
  v_dot2c_f32_bf16 v11, v17, v7
  v_dot2c_f32_bf16 v12, v18, v6
  v_dot2c_f32_bf16 v13, v18, v7
  v_dot2c_f32_bf16 v14, v19, v6
  v_dot2c_f32_bf16 v15, v19, v7
  s_waitcnt vmcnt(26)
  v_dot2c_f32_bf16 v8, v20, v6
  v_dot2c_f32_bf16 v9, v20, v7
  v_dot2c_f32_bf16 v10, v21, v6
  v_dot2c_f32_bf16 v11, v21, v7
  v_dot2c_f32_bf16 v12, v22, v6
  v_dot2c_f32_bf16 v13, v22, v7
  v_dot2c_f32_bf16 v14, v23, v6
  v_dot2c_f32_bf16 v15, v23, v7
  s_waitcnt vmcnt(25)
  v_dot2c_f32_bf16 v8, v24, v6
  v_dot2c_f32_bf16 v9, v24, v7
  v_dot2c_f32_bf16 v10, v25, v6
  v_dot2c_f32_bf16 v11, v25, v7
  v_dot2c_f32_bf16 v12, v26, v6
  v_dot2c_f32_bf16 v13, v26, v7
  v_dot2c_f32_bf16 v14, v27, v6
  v_dot2c_f32_bf16 v15, v27, v7
  s_waitcnt vmcnt(24)
  v_dot2c_f32_bf16 v8, v28, v6
  v_dot2c_f32_bf16 v9, v28, v7
  v_dot2c_f32_bf16 v10, v29, v6
  v_dot2c_f32_bf16 v11, v29, v7
  v_dot2c_f32_bf16 v12, v30, v6
  v_dot2c_f32_bf16 v13, v30, v7
  v_dot2c_f32_bf16 v14, v31, v6
  v_dot2c_f32_bf16 v15, v31, v7
  s_waitcnt vmcnt(23)
  v_dot2c_f32_bf16 v8, v32, v6
  v_dot2c_f32_bf16 v9, v32, v7
  v_dot2c_f32_bf16 v10, v33, v6
  v_dot2c_f32_bf16 v11, v33, v7
  v_dot2c_f32_bf16 v12, v34, v6
  v_dot2c_f32_bf16 v13, v34, v7
  v_dot2c_f32_bf16 v14, v35, v6
  v_dot2c_f32_bf16 v15, v35, v7
  s_waitcnt vmcnt(22)
  v_dot2c_f32_bf16 v8, v36, v6
  v_dot2c_f32_bf16 v9, v36, v7
  v_dot2c_f32_bf16 v10, v37, v6
  v_dot2c_f32_bf16 v11, v37, v7
  v_dot2c_f32_bf16 v12, v38, v6
  v_dot2c_f32_bf16 v13, v38, v7
  v_dot2c_f32_bf16 v14, v39, v6
  v_dot2c_f32_bf16 v15, v39, v7
  s_waitcnt vmcnt(21)
  v_dot2c_f32_bf16 v8, v40, v6
  v_dot2c_f32_bf16 v9, v40, v7
  v_dot2c_f32_bf16 v10, v41, v6
  v_dot2c_f32_bf16 v11, v41, v7
  v_dot2c_f32_bf16 v12, v42, v6
  v_dot2c_f32_bf16 v13, v42, v7
  v_dot2c_f32_bf16 v14, v43, v6
  v_dot2c_f32_bf16 v15, v43, v7
  s_waitcnt vmcnt(20)
  v_dot2c_f32_bf16 v8, v44, v6
  v_dot2c_f32_bf16 v9, v44, v7
  v_dot2c_f32_bf16 v10, v45, v6
  v_dot2c_f32_bf16 v11, v45, v7
  v_dot2c_f32_bf16 v12, v46, v6
  v_dot2c_f32_bf16 v13, v46, v7
  v_dot2c_f32_bf16 v14, v47, v6
  v_dot2c_f32_bf16 v15, v47, v7
  s_waitcnt vmcnt(19)
  v_dot2c_f32_bf16 v8, v48, v6
  v_dot2c_f32_bf16 v9, v48, v7
  v_dot2c_f32_bf16 v10, v49, v6
  v_dot2c_f32_bf16 v11, v49, v7
  v_dot2c_f32_bf16 v12, v50, v6
  v_dot2c_f32_bf16 v13, v50, v7
  v_dot2c_f32_bf16 v14, v51, v6
  v_dot2c_f32_bf16 v15, v51, v7
  s_waitcnt vmcnt(18)
  v_dot2c_f32_bf16 v8, v52, v6
  v_dot2c_f32_bf16 v9, v52, v7
  v_dot2c_f32_bf16 v10, v53, v6
  v_dot2c_f32_bf16 v11, v53, v7
  v_dot2c_f32_bf16 v12, v54, v6
  v_dot2c_f32_bf16 v13, v54, v7
  v_dot2c_f32_bf16 v14, v55, v6
  v_dot2c_f32_bf16 v15, v55, v7
  s_waitcnt vmcnt(17)
  v_dot2c_f32_bf16 v8, v56, v6
  v_dot2c_f32_bf16 v9, v56, v7
  v_dot2c_f32_bf16 v10, v57, v6
  v_dot2c_f32_bf16 v11, v57, v7
  v_dot2c_f32_bf16 v12, v58, v6
  v_dot2c_f32_bf16 v13, v58, v7
  v_dot2c_f32_bf16 v14, v59, v6
  v_dot2c_f32_bf16 v15, v59, v7
  s_waitcnt vmcnt(16)
  v_dot2c_f32_bf16 v8, v60, v6
  v_dot2c_f32_bf16 v9, v60, v7
  v_dot2c_f32_bf16 v10, v61, v6
  v_dot2c_f32_bf16 v11, v61, v7
  v_dot2c_f32_bf16 v12, v62, v6
  v_dot2c_f32_bf16 v13, v62, v7
  v_dot2c_f32_bf16 v14, v63, v6
  v_dot2c_f32_bf16 v15, v63, v7
  s_waitcnt vmcnt(15)
  v_dot2c_f32_bf16 v8, v64, v6
  v_dot2c_f32_bf16 v9, v64, v7
  v_dot2c_f32_bf16 v10, v65, v6
  v_dot2c_f32_bf16 v11, v65, v7
  v_dot2c_f32_bf16 v12, v66, v6
  v_dot2c_f32_bf16 v13, v66, v7
  v_dot2c_f32_bf16 v14, v67, v6
  v_dot2c_f32_bf16 v15, v67, v7
  s_waitcnt vmcnt(14)
  v_dot2c_f32_bf16 v8, v68, v6
  v_dot2c_f32_bf16 v9, v68, v7
  v_dot2c_f32_bf16 v10, v69, v6
  v_dot2c_f32_bf16 v11, v69, v7
  v_dot2c_f32_bf16 v12, v70, v6
  v_dot2c_f32_bf16 v13, v70, v7
  v_dot2c_f32_bf16 v14, v71, v6
  v_dot2c_f32_bf16 v15, v71, v7
  s_waitcnt vmcnt(13)
  v_dot2c_f32_bf16 v8, v72, v6
  v_dot2c_f32_bf16 v9, v72, v7
  v_dot2c_f32_bf16 v10, v73, v6
  v_dot2c_f32_bf16 v11, v73, v7
  v_dot2c_f32_bf16 v12, v74, v6
  v_dot2c_f32_bf16 v13, v74, v7
  v_dot2c_f32_bf16 v14, v75, v6
  v_dot2c_f32_bf16 v15, v75, v7
  s_waitcnt vmcnt(12)
  v_dot2c_f32_bf16 v8, v76, v6
  v_dot2c_f32_bf16 v9, v76, v7
  v_dot2c_f32_bf16 v10, v77, v6
  v_dot2c_f32_bf16 v11, v77, v7
  v_dot2c_f32_bf16 v12, v78, v6
  v_dot2c_f32_bf16 v13, v78, v7
  v_dot2c_f32_bf16 v14, v79, v6
  v_dot2c_f32_bf16 v15, v79, v7
  s_waitcnt vmcnt(11)
  v_dot2c_f32_bf16 v8, v80, v6
  v_dot2c_f32_bf16 v9, v80, v7
  v_dot2c_f32_bf16 v10, v81, v6
  v_dot2c_f32_bf16 v11, v81, v7
  v_dot2c_f32_bf16 v12, v82, v6
  v_dot2c_f32_bf16 v13, v82, v7
  v_dot2c_f32_bf16 v14, v83, v6
  v_dot2c_f32_bf16 v15, v83, v7
  s_waitcnt vmcnt(10)
  v_dot2c_f32_bf16 v8, v84, v6
  v_dot2c_f32_bf16 v9, v84, v7
  v_dot2c_f32_bf16 v10, v85, v6
  v_dot2c_f32_bf16 v11, v85, v7
  v_dot2c_f32_bf16 v12, v86, v6
  v_dot2c_f32_bf16 v13, v86, v7
  v_dot2c_f32_bf16 v14, v87, v6
  v_dot2c_f32_bf16 v15, v87, v7
  s_waitcnt vmcnt(9)
  v_dot2c_f32_bf16 v8, v88, v6
  v_dot2c_f32_bf16 v9, v88, v7
  v_dot2c_f32_bf16 v10, v89, v6
  v_dot2c_f32_bf16 v11, v89, v7
  v_dot2c_f32_bf16 v12, v90, v6
  v_dot2c_f32_bf16 v13, v90, v7
  v_dot2c_f32_bf16 v14, v91, v6
  v_dot2c_f32_bf16 v15, v91, v7
  s_waitcnt vmcnt(8)
  v_dot2c_f32_bf16 v8, v92, v6
  v_dot2c_f32_bf16 v9, v92, v7
  v_dot2c_f32_bf16 v10, v93, v6
  v_dot2c_f32_bf16 v11, v93, v7
  v_dot2c_f32_bf16 v12, v94, v6
  v_dot2c_f32_bf16 v13, v94, v7
  v_dot2c_f32_bf16 v14, v95, v6
  v_dot2c_f32_bf16 v15, v95, v7
  s_waitcnt vmcnt(7)
  v_dot2c_f32_bf16 v8, v96, v6
  v_dot2c_f32_bf16 v9, v96, v7
  v_dot2c_f32_bf16 v10, v97, v6
  v_dot2c_f32_bf16 v11, v97, v7
  v_dot2c_f32_bf16 v12, v98, v6
  v_dot2c_f32_bf16 v13, v98, v7
  v_dot2c_f32_bf16 v14, v99, v6
  v_dot2c_f32_bf16 v15, v99, v7
  s_waitcnt vmcnt(6)
  v_dot2c_f32_bf16 v8, v100, v6
  v_dot2c_f32_bf16 v9, v100, v7
  v_dot2c_f32_bf16 v10, v101, v6
  v_dot2c_f32_bf16 v11, v101, v7
  v_dot2c_f32_bf16 v12, v102, v6
  v_dot2c_f32_bf16 v13, v102, v7
  v_dot2c_f32_bf16 v14, v103, v6
  v_dot2c_f32_bf16 v15, v103, v7
  s_waitcnt vmcnt(5)
  v_dot2c_f32_bf16 v8, v104, v6
  v_dot2c_f32_bf16 v9, v104, v7
  v_dot2c_f32_bf16 v10, v105, v6
  v_dot2c_f32_bf16 v11, v105, v7
  v_dot2c_f32_bf16 v12, v106, v6
  v_dot2c_f32_bf16 v13, v106, v7
  v_dot2c_f32_bf16 v14, v107, v6
  v_dot2c_f32_bf16 v15, v107, v7
  s_waitcnt vmcnt(4)
  v_dot2c_f32_bf16 v8, v108, v6
  v_dot2c_f32_bf16 v9, v108, v7
  v_dot2c_f32_bf16 v10, v109, v6
  v_dot2c_f32_bf16 v11, v109, v7
  v_dot2c_f32_bf16 v12, v110, v6
  v_dot2c_f32_bf16 v13, v110, v7
  v_dot2c_f32_bf16 v14, v111, v6
  v_dot2c_f32_bf16 v15, v111, v7
  s_waitcnt vmcnt(3)
  v_dot2c_f32_bf16 v8, v112, v6
  v_dot2c_f32_bf16 v9, v112, v7
  v_dot2c_f32_bf16 v10, v113, v6
  v_dot2c_f32_bf16 v11, v113, v7
  v_dot2c_f32_bf16 v12, v114, v6
  v_dot2c_f32_bf16 v13, v114, v7
  v_dot2c_f32_bf16 v14, v115, v6
  v_dot2c_f32_bf16 v15, v115, v7
  s_waitcnt vmcnt(2)
  v_dot2c_f32_bf16 v8, v116, v6
  v_dot2c_f32_bf16 v9, v116, v7
  v_dot2c_f32_bf16 v10, v117, v6
  v_dot2c_f32_bf16 v11, v117, v7
  v_dot2c_f32_bf16 v12, v118, v6
  v_dot2c_f32_bf16 v13, v118, v7
  v_dot2c_f32_bf16 v14, v119, v6
  v_dot2c_f32_bf16 v15, v119, v7
  s_waitcnt vmcnt(1)
  v_dot2c_f32_bf16 v8, v120, v6
  v_dot2c_f32_bf16 v9, v120, v7
  v_dot2c_f32_bf16 v10, v121, v6
  v_dot2c_f32_bf16 v11, v121, v7
  v_dot2c_f32_bf16 v12, v122, v6
  v_dot2c_f32_bf16 v13, v122, v7
  v_dot2c_f32_bf16 v14, v123, v6
  v_dot2c_f32_bf16 v15, v123, v7
  s_waitcnt vmcnt(0)
  v_dot2c_f32_bf16 v8, v124, v6
  v_dot2c_f32_bf16 v9, v124, v7
  v_dot2c_f32_bf16 v10, v125, v6
  v_dot2c_f32_bf16 v11, v125, v7
  v_dot2c_f32_bf16 v12, v126, v6
  v_dot2c_f32_bf16 v13, v126, v7
  v_dot2c_f32_bf16 v14, v127, v6
  v_dot2c_f32_bf16 v15, v127, v7
  s_nop 2
  v_mov_b32 v16, v8
  v_mov_b32 v17, v9
  v_mov_b32 v18, v10
  v_mov_b32 v19, v11
  v_mov_b32 v20, v12
  v_mov_b32 v21, v13
  v_mov_b32 v22, v14
  v_mov_b32 v23, v15
  s_nop 1
  v_permlane16_swap_b32 v16, v8
  v_permlane16_swap_b32 v17, v9
  v_permlane16_swap_b32 v18, v10
  v_permlane16_swap_b32 v19, v11
  v_permlane16_swap_b32 v20, v12
  v_permlane16_swap_b32 v21, v13
  v_permlane16_swap_b32 v22, v14
  v_permlane16_swap_b32 v23, v15
  s_nop 1
  v_add_f32 v8, v8, v16
  v_add_f32 v9, v9, v17
  v_add_f32 v10, v10, v18
  v_add_f32 v11, v11, v19
  v_add_f32 v12, v12, v20
  v_add_f32 v13, v13, v21
  v_add_f32 v14, v14, v22
  v_add_f32 v15, v15, v23
  v_mov_b32 v16, v8
  v_mov_b32 v17, v9
  v_mov_b32 v18, v10
  v_mov_b32 v19, v11
  v_mov_b32 v20, v12
  v_mov_b32 v21, v13
  v_mov_b32 v22, v14
  v_mov_b32 v23, v15
  s_nop 1
  v_permlane32_swap_b32 v16, v8
  v_permlane32_swap_b32 v17, v9
  v_permlane32_swap_b32 v18, v10
  v_permlane32_swap_b32 v19, v11
  v_permlane32_swap_b32 v20, v12
  v_permlane32_swap_b32 v21, v13
  v_permlane32_swap_b32 v22, v14
  v_permlane32_swap_b32 v23, v15
  s_nop 1
  v_add_f32 v8, v8, v16
  v_add_f32 v9, v9, v17
  v_add_f32 v10, v10, v18
  v_add_f32 v11, v11, v19
  v_add_f32 v12, v12, v20
  v_add_f32 v13, v13, v21
  v_add_f32 v14, v14, v22
  v_add_f32 v15, v15, v23
  v_lshlrev_b32 v4, 5, v3
  s_lshl_b32 s56, s52, 9
  v_add_u32 v4, s56, v4
  ds_write_b128 v4, v[8:11] offset:49152
  ds_write_b128 v4, v[12:15] offset:49168
  s_waitcnt lgkmcnt(0)
  s_barrier
  s_cmp_lg_u32 s52, 0
  s_cbranch_scc1 Lcs_e_21
  v_lshlrev_b32 v4, 3, v1
  ds_read_b64 v[16:17], v4 offset:49152
  ds_read_b64 v[18:19], v4 offset:49664
  ds_read_b64 v[20:21], v4 offset:50176
  ds_read_b64 v[22:23], v4 offset:50688
  s_waitcnt lgkmcnt(0)
  v_add_f32 v16, v16, v18
  v_add_f32 v17, v17, v19
  v_add_f32 v20, v20, v22
  v_add_f32 v21, v21, v23
  v_add_f32 v16, v16, v20
  v_add_f32 v17, v17, v21
  s_cmp_lt_u32 s59, 14
  s_cselect_b32 s56, 0, 7168
  s_lshl_b32 s57, s64, 9
  s_add_u32 s56, s56, s57
  s_add_u32 s56, s56, 0xd00000
  buffer_store_dwordx2 v[16:17], v4, s[24:27], s56 offen sc1
  s_waitcnt vmcnt(0)
  s_lshl_b32 s12, s59, 2
  s_add_u32 s12, s12, 0xd82800
  s_add_u32 s56, s12, 0x8000
  buffer_store_dword v140, v141, s[24:27], s56 offen
  buffer_store_dword v140, v141, s[24:27], s12 offen sc0 sc1
Lcs_e_21:
  s_branch Lend
Lloader:
  s_mul_i32 s56, s55, 192
  v_add_u32 v6, s56, v1
  v_mul_u32_u24 v7, 2731, v6
  v_lshrrev_b32 v7, 16, v7
  v_mul_u32_u24 v8, 24, v7
  v_sub_u32 v6, v6, v8
  v_mul_u32_u24 v2, 2688, v7
  v_lshrrev_b32 v8, 3, v6
  v_mul_u32_u24 v8, 896, v8
  v_add_u32 v2, v2, v8
  v_bfe_u32 v8, v7, 1, 1
  v_bfe_u32 v9, v7, 3, 1
  v_lshlrev_b32 v9, 1, v9
  v_or_b32 v8, v8, v9
  v_lshlrev_b32 v8, 1, v8
  v_and_b32 v6, 7, v6
  v_xor_b32 v6, v6, v8
  v_min_u32 v6, 6, v6
  v_lshlrev_b32 v6, 4, v6
  v_add_u32 v2, v2, v6
  v_add_u32 v6, s56, v1
  v_add_u32 v6, 64, v6
  v_mul_u32_u24 v7, 2731, v6
  v_lshrrev_b32 v7, 16, v7
  v_mul_u32_u24 v8, 24, v7
  v_sub_u32 v6, v6, v8
  v_mul_u32_u24 v3, 2688, v7
  v_lshrrev_b32 v8, 3, v6
  v_mul_u32_u24 v8, 896, v8
  v_add_u32 v3, v3, v8
  v_bfe_u32 v8, v7, 1, 1
  v_bfe_u32 v9, v7, 3, 1
  v_lshlrev_b32 v9, 1, v9
  v_or_b32 v8, v8, v9
  v_lshlrev_b32 v8, 1, v8
  v_and_b32 v6, 7, v6
  v_xor_b32 v6, v6, v8
  v_min_u32 v6, 6, v6
  v_lshlrev_b32 v6, 4, v6
  v_add_u32 v3, v3, v6
  v_add_u32 v6, s56, v1
  v_add_u32 v6, 128, v6
  v_mul_u32_u24 v7, 2731, v6
  v_lshrrev_b32 v7, 16, v7
  v_mul_u32_u24 v8, 24, v7
  v_sub_u32 v6, v6, v8
  v_mul_u32_u24 v4, 2688, v7
  v_lshrrev_b32 v8, 3, v6
  v_mul_u32_u24 v8, 896, v8
  v_add_u32 v4, v4, v8
  v_bfe_u32 v8, v7, 1, 1
  v_bfe_u32 v9, v7, 3, 1
  v_lshlrev_b32 v9, 1, v9
  v_or_b32 v8, v8, v9
  v_lshlrev_b32 v8, 1, v8
  v_and_b32 v6, 7, v6
  v_xor_b32 v6, v6, v8
  v_min_u32 v6, 6, v6
  v_lshlrev_b32 v6, 4, v6
  v_add_u32 v4, v4, v6
  s_mul_i32 s62, s60, 112
  s_mul_i32 s63, s55, 3072
  s_add_u32 s63, s63, 71680
  v_lshrrev_b32 v6, 3, v1
  v_and_b32 v7, 7, v1
  v_xor_b32 v7, v7, v6
  v_lshlrev_b32 v7, 4, v7
  v_mul_u32_u24 v5, 896, v6
  v_add_u32 v5, v5, v7
  s_lshl_b32 s56, s55, 4
  s_add_u32 s56, s56, s61
  s_mul_i32 s64, s56, 896
  s_lshl_b32 s66, s55, 11
  s_add_u32 s66, s66, 2048
  s_max_u32 s56, s61, 16
  s_sub_u32 s56, s56, 16
  s_and_b32 s57, s55, 1
  s_lshl_b32 s67, s57, 10
  s_cmp_eq_u32 s57, 0
  s_cselect_b32 s70, 0xffffff00, -1
  s_mov_b32 s71, -1
  s_lshl_b32 s57, s57, 3
  s_add_u32 s56, s56, s57
  s_mul_i32 s65, s56, 896
  s_lshr_b32 s57, s55, 1
  s_lshl_b32 s68, s57, 7
  s_mul_i32 s69, s57, 10240
  s_waitcnt lgkmcnt(0)
  s_mov_b32 s32, s6
  s_mov_b32 s33, s7
  s_mov_b32 s34, 0x126000
  s_mov_b32 s35, 0x20000
  s_mov_b32 s28, s4
  s_mov_b32 s29, s5
  s_mov_b32 s30, 0x1c0000
  s_mov_b32 s31, 0x20000
  s_add_u32 m0, s66, 0
  s_add_u32 s56, s64, 0
  buffer_load_dwordx4 v5, s[28:31], s56 offen lds
  s_add_u32 m0, s66, 1024
  s_add_u32 s56, s64, 7168
  buffer_load_dwordx4 v5, s[28:31], s56 offen lds
  s_add_u32 m0, s66, 10240
  s_add_u32 s56, s64, 128
  buffer_load_dwordx4 v5, s[28:31], s56 offen lds
  s_add_u32 m0, s66, 11264
  s_add_u32 s56, s64, 7296
  buffer_load_dwordx4 v5, s[28:31], s56 offen lds
  s_add_u32 s57, s67, s69
  s_add_u32 m0, s57, 0
  s_add_u32 s56, s65, s68
  s_add_u32 s56, s56, 0
  s_mov_b64 exec, s[70:71]
  buffer_load_dwordx4 v5, s[28:31], s56 offen lds
  s_mov_b64 exec, -1
  s_add_u32 m0, s63, 0
  s_add_u32 s56, s62, 0
  buffer_load_dwordx4 v2, s[32:35], s56 offen lds
  s_add_u32 m0, s63, 1024
  s_add_u32 s56, s62, 0
  buffer_load_dwordx4 v3, s[32:35], s56 offen lds
  s_add_u32 m0, s63, 2048
  s_add_u32 s56, s62, 0
  buffer_load_dwordx4 v4, s[32:35], s56 offen lds
  s_add_u32 m0, s63, 12288
  s_add_u32 s56, s62, 86016
  buffer_load_dwordx4 v2, s[32:35], s56 offen lds
  s_add_u32 m0, s63, 13312
  s_add_u32 s56, s62, 86016
  buffer_load_dwordx4 v3, s[32:35], s56 offen lds
  s_add_u32 m0, s63, 14336
  s_add_u32 s56, s62, 86016
  buffer_load_dwordx4 v4, s[32:35], s56 offen lds
  s_add_u32 m0, s63, 24576
  s_add_u32 s56, s62, 172032
  buffer_load_dwordx4 v2, s[32:35], s56 offen lds
  s_add_u32 m0, s63, 25600
  s_add_u32 s56, s62, 172032
  buffer_load_dwordx4 v3, s[32:35], s56 offen lds
  s_add_u32 m0, s63, 26624
  s_add_u32 s56, s62, 172032
  buffer_load_dwordx4 v4, s[32:35], s56 offen lds
  s_mov_b32 s24, s22
  s_mov_b32 s25, s23
  s_mov_b32 s26, 0x10000000
  s_mov_b32 s27, 0x20000
  s_mov_b32 s36, s8
  s_mov_b32 s37, s9
  s_mov_b32 s38, 0x62000
  s_mov_b32 s39, 0x20000
  s_cmp_lt_u32 s55, 2
  s_cselect_b32 s40, s12, s14
  s_cselect_b32 s41, s13, s15
  s_mov_b32 s42, 0x188000
  s_mov_b32 s43, 0x20000
  s_mov_b32 s44, s16
  s_mov_b32 s45, s17
  s_mov_b32 s46, 0x188000
  s_mov_b32 s47, 0x20000
  s_mov_b32 s48, s18
  s_mov_b32 s49, s19
  s_mov_b32 s50, 0x1c0000
  s_mov_b32 s51, 0x20000
  s_mov_b32 s8, s12
  s_mov_b32 s9, s13
  s_mov_b32 s10, s14
  s_mov_b32 s11, s15
  s_mov_b32 s4, s20
  s_mov_b32 s5, s21
  s_mov_b32 s6, 0x100
  s_mov_b32 s7, 0x20000
  s_waitcnt vmcnt(6)
  s_barrier
  s_add_u32 m0, s63, 36864
  s_add_u32 s56, s62, 258048
  buffer_load_dwordx4 v2, s[32:35], s56 offen lds
  s_add_u32 m0, s63, 37888
  s_add_u32 s56, s62, 258048
  buffer_load_dwordx4 v3, s[32:35], s56 offen lds
  s_add_u32 m0, s63, 38912
  s_add_u32 s56, s62, 258048
  buffer_load_dwordx4 v4, s[32:35], s56 offen lds
  s_waitcnt vmcnt(6)
  s_barrier
  s_add_u32 m0, s66, 20480
  s_add_u32 s56, s64, 256
  buffer_load_dwordx4 v5, s[28:31], s56 offen lds
  s_add_u32 m0, s66, 21504
  s_add_u32 s56, s64, 7424
  buffer_load_dwordx4 v5, s[28:31], s56 offen lds
  s_add_u32 m0, s66, 30720
  s_add_u32 s56, s64, 384
  buffer_load_dwordx4 v5, s[28:31], s56 offen lds
  s_add_u32 m0, s66, 31744
  s_add_u32 s56, s64, 7552
  buffer_load_dwordx4 v5, s[28:31], s56 offen lds
  s_add_u32 s57, s67, s69
  s_add_u32 m0, s57, 20480
  s_add_u32 s56, s65, s68
  s_add_u32 s56, s56, 256
  s_mov_b64 exec, s[70:71]
  buffer_load_dwordx4 v5, s[28:31], s56 offen lds
  s_mov_b64 exec, -1
  s_add_u32 m0, s63, 49152
  s_add_u32 s56, s62, 344064
  buffer_load_dwordx4 v2, s[32:35], s56 offen lds
  s_waitcnt vmcnt(9)
  s_barrier
  s_add_u32 m0, s63, 50176
  s_add_u32 s56, s62, 344064
  buffer_load_dwordx4 v3, s[32:35], s56 offen lds
  s_add_u32 m0, s63, 51200
  s_add_u32 s56, s62, 344064
  buffer_load_dwordx4 v4, s[32:35], s56 offen lds
  s_add_u32 m0, s63, 61440
  s_add_u32 s56, s62, 430080
  buffer_load_dwordx4 v2, s[32:35], s56 offen lds
  s_add_u32 m0, s63, 62464
  s_add_u32 s56, s62, 430080
  buffer_load_dwordx4 v3, s[32:35], s56 offen lds
  s_add_u32 m0, s63, 63488
  s_add_u32 s56, s62, 430080
  buffer_load_dwordx4 v4, s[32:35], s56 offen lds
  s_add_u32 m0, s63, 73728
  s_add_u32 s56, s62, 516096
  buffer_load_dwordx4 v2, s[32:35], s56 offen lds
  s_waitcnt vmcnt(12)
  s_barrier
  s_add_u32 m0, s63, 74752
  s_add_u32 s56, s62, 516096
  buffer_load_dwordx4 v3, s[32:35], s56 offen lds
  s_add_u32 m0, s63, 75776
  s_add_u32 s56, s62, 516096
  buffer_load_dwordx4 v4, s[32:35], s56 offen lds
  s_add_u32 m0, s63, 0
  s_add_u32 s56, s62, 602112
  buffer_load_dwordx4 v2, s[32:35], s56 offen lds
  s_add_u32 m0, s63, 1024
  s_add_u32 s56, s62, 602112
  buffer_load_dwordx4 v3, s[32:35], s56 offen lds
  s_add_u32 m0, s63, 2048
  s_add_u32 s56, s62, 602112
  buffer_load_dwordx4 v4, s[32:35], s56 offen lds
  s_add_u32 m0, s66, 40960
  s_add_u32 s56, s64, 512
  buffer_load_dwordx4 v5, s[28:31], s56 offen lds
  s_waitcnt vmcnt(10)
  s_barrier
  s_add_u32 m0, s66, 41984
  s_add_u32 s56, s64, 7680
  buffer_load_dwordx4 v5, s[28:31], s56 offen lds
  s_add_u32 m0, s66, 51200
  s_add_u32 s56, s64, 640
  buffer_load_dwordx4 v5, s[28:31], s56 offen lds
  s_add_u32 m0, s66, 52224
  s_add_u32 s56, s64, 7808
  buffer_load_dwordx4 v5, s[28:31], s56 offen lds
  s_add_u32 s57, s67, s69
  s_add_u32 m0, s57, 40960
  s_add_u32 s56, s65, s68
  s_add_u32 s56, s56, 512
  s_mov_b64 exec, s[70:71]
  buffer_load_dwordx4 v5, s[28:31], s56 offen lds
  s_mov_b64 exec, -1
  s_add_u32 m0, s63, 12288
  s_add_u32 s56, s62, 688128
  buffer_load_dwordx4 v2, s[32:35], s56 offen lds
  s_add_u32 m0, s63, 13312
  s_add_u32 s56, s62, 688128
  buffer_load_dwordx4 v3, s[32:35], s56 offen lds
  s_waitcnt vmcnt(13)
  s_barrier
  s_add_u32 m0, s63, 14336
  s_add_u32 s56, s62, 688128
  buffer_load_dwordx4 v4, s[32:35], s56 offen lds
  s_add_u32 m0, s63, 24576
  s_add_u32 s56, s62, 774144
  buffer_load_dwordx4 v2, s[32:35], s56 offen lds
  s_add_u32 m0, s63, 25600
  s_add_u32 s56, s62, 774144
  buffer_load_dwordx4 v3, s[32:35], s56 offen lds
  s_add_u32 m0, s63, 26624
  s_add_u32 s56, s62, 774144
  buffer_load_dwordx4 v4, s[32:35], s56 offen lds
  s_add_u32 m0, s63, 36864
  s_add_u32 s56, s62, 860160
  buffer_load_dwordx4 v2, s[32:35], s56 offen lds
  s_add_u32 m0, s63, 37888
  s_add_u32 s56, s62, 860160
  buffer_load_dwordx4 v3, s[32:35], s56 offen lds
  buffer_load_dword v140, v141, s[4:7], 0 offen sc0 sc1
  s_waitcnt vmcnt(17)
  s_barrier
  s_add_u32 m0, s63, 38912
  s_add_u32 s56, s62, 860160
  buffer_load_dwordx4 v4, s[32:35], s56 offen lds
  s_add_u32 m0, s63, 49152
  s_add_u32 s56, s62, 946176
  buffer_load_dwordx4 v2, s[32:35], s56 offen lds
  s_add_u32 m0, s63, 50176
  s_add_u32 s56, s62, 946176
  buffer_load_dwordx4 v3, s[32:35], s56 offen lds
  s_add_u32 m0, s63, 51200
  s_add_u32 s56, s62, 946176
  buffer_load_dwordx4 v4, s[32:35], s56 offen lds
  s_add_u32 m0, s66, 61440
  s_add_u32 s56, s64, 768
  buffer_load_dwordx4 v5, s[28:31], s56 offen lds
  s_add_u32 m0, s66, 62464
  s_add_u32 s56, s64, 7936
  buffer_load_dwordx4 v5, s[28:31], s56 offen lds
  s_waitcnt vmcnt(20)
  s_barrier
  s_add_u32 m0, s67, 61440
  s_add_u32 s56, s65, 768
  s_mov_b64 exec, s[70:71]
  buffer_load_dwordx4 v5, s[28:31], s56 offen lds
  s_mov_b64 exec, -1
  s_add_u32 m0, s63, 61440
  s_add_u32 s56, s62, 1032192
  buffer_load_dwordx4 v2, s[32:35], s56 offen lds
  s_add_u32 m0, s63, 62464
  s_add_u32 s56, s62, 1032192
  buffer_load_dwordx4 v3, s[32:35], s56 offen lds
  s_add_u32 m0, s63, 63488
  s_add_u32 s56, s62, 1032192
  buffer_load_dwordx4 v4, s[32:35], s56 offen lds
  s_waitcnt vmcnt(16)
  s_barrier
  s_add_u32 m0, s63, 73728
  s_add_u32 s56, s62, 1118208
  buffer_load_dwordx4 v2, s[32:35], s56 offen lds
  s_add_u32 m0, s63, 74752
  s_add_u32 s56, s62, 1118208
  buffer_load_dwordx4 v3, s[32:35], s56 offen lds
  s_add_u32 m0, s63, 75776
  s_add_u32 s56, s62, 1118208
  buffer_load_dwordx4 v4, s[32:35], s56 offen lds
  s_mul_i32 s56, s54, 9363
  s_lshr_b32 s56, s56, 16
  s_mul_i32 s57, s56, 7
  s_sub_u32 s60, s54, s57
  s_lshl_b32 s59, s53, 2
  s_add_u32 s59, s59, s56
  v_lshrrev_b32 v6, 3, v1
  v_and_b32 v7, 2, v6
  v_lshlrev_b32 v7, 1, v7
  v_and_b32 v8, 7, v1
  v_xor_b32 v7, v7, v8
  v_lshlrev_b32 v7, 4, v7
  v_mul_u32_u24 v6, 896, v6
  v_add_u32 v10, v6, v7
  v_lshlrev_b32 v11, 4, v1
  s_lshl_b32 s61, s60, 7
  s_mul_i32 s56, s55, 14336
  s_add_u32 s61, s61, s56
  s_lshl_b32 s63, s55, 10
  s_lshl_b32 s64, s55, 11
  s_lshl_b32 s56, s59, 1
  s_mul_i32 s56, s56, 28672
  s_add_u32 s62, s56, 0x0
  s_add_u32 s62, s62, s63
  s_waitcnt vmcnt(16)
  s_barrier
  s_add_u32 m0, s64, 71680
  s_add_u32 s56, s61, 0
  s_add_u32 s57, s61, 6144
  buffer_load_dwordx4 v10, s[36:39], s56 offen lds
  buffer_load_dwordx4 v10, s[36:39], s57 offen offset:1024 lds
  s_waitcnt vmcnt(14)
  s_barrier
  s_add_u32 m0, s64, 79872
  s_add_u32 s56, s61, 57344
  s_add_u32 s57, s61, 63488
  buffer_load_dwordx4 v10, s[36:39], s56 offen lds
  buffer_load_dwordx4 v10, s[36:39], s57 offen offset:1024 lds
  s_add_u32 m0, s64, 88064
  s_add_u32 s56, s61, 114688
  s_add_u32 s57, s61, 120832
  buffer_load_dwordx4 v10, s[36:39], s56 offen lds
  buffer_load_dwordx4 v10, s[36:39], s57 offen offset:1024 lds
  s_waitcnt vmcnt(15)
  s_barrier
  s_add_u32 m0, s64, 96256
  s_add_u32 s56, s61, 172032
  s_add_u32 s57, s61, 178176
  buffer_load_dwordx4 v10, s[36:39], s56 offen lds
  buffer_load_dwordx4 v10, s[36:39], s57 offen offset:1024 lds
  s_waitcnt vmcnt(11)
  s_barrier
  s_add_u32 m0, s64, 104448
  s_add_u32 s56, s61, 229376
  s_add_u32 s57, s61, 235520
  buffer_load_dwordx4 v10, s[36:39], s56 offen lds
  buffer_load_dwordx4 v10, s[36:39], s57 offen offset:1024 lds
  s_add_u32 m0, s64, 112640
  s_add_u32 s56, s61, 286720
  s_add_u32 s57, s61, 292864
  buffer_load_dwordx4 v10, s[36:39], s56 offen lds
  buffer_load_dwordx4 v10, s[36:39], s57 offen offset:1024 lds
  s_waitcnt vmcnt(12)
  s_barrier
  s_cmp_ge_u32 s54, 28
  s_cbranch_scc1 Ll_job
  s_barrier
  s_add_u32 m0, s64, 120832
  s_add_u32 s56, s61, 344064
  s_add_u32 s57, s61, 350208
  buffer_load_dwordx4 v10, s[36:39], s56 offen lds
  buffer_load_dwordx4 v10, s[36:39], s57 offen offset:1024 lds
  s_cmp_lg_u32 s55, 0
  s_cbranch_scc1 Lmw_100001
  v_min_u32 v6, 48, v1
  s_mul_i32 s56, s2, 49
  v_add_u32 v6, s56, v6
  v_lshlrev_b32 v6, 7, v6
  buffer_load_dword v139, v6, s[44:47], 0 offen
Lmw_100001:
  s_sub_u32 s56, s55, 1
  s_cmp_gt_u32 s56, 1
  s_cbranch_scc1 Lmw_100002
  v_min_u32 v6, 48, v1
  s_mul_i32 s56, s2, 49
  v_add_u32 v6, s56, v6
  v_lshlrev_b32 v6, 7, v6
  buffer_load_dword v139, v6, s[40:43], 0 offen
Lmw_100002:
  v_cmp_ne_u32 vcc, 0, v140
  s_cbranch_vccnz Ltz_100003
  s_mov_b32 s58, 0
Ltagw_100005:
  buffer_load_dword v140, v141, s[4:7], 0 offen sc0 sc1
  s_add_u32 s58, s58, 1
  s_cmp_gt_u32 s58, 0x40000
  s_cbranch_scc1 Ltagok_100004
  s_waitcnt vmcnt(0)
  v_cmp_eq_u32 vcc, 0, v140
  s_cbranch_vccnz Ltagw_100005
Ltagok_100004:
Ltz_100003:
  s_barrier
  s_mul_i32 s56, s54, 4682
  s_lshr_b32 s56, s56, 16
  s_mul_i32 s57, s56, 14
  s_sub_u32 s67, s54, s57
  s_lshl_b32 s66, s53, 1
  s_add_u32 s66, s66, s56
  s_lshl_b32 s68, s67, 8
  v_lshrrev_b32 v2, 3, v1
  s_and_b32 s56, s55, 1
  s_lshl_b32 s56, s56, 3
  v_add_u32 v2, s56, v2
  v_mul_u32_u24 v13, 3584, v2
  v_bfe_u32 v3, v1, 4, 1
  s_lshr_b32 s56, s55, 1
  s_lshl_b32 s56, s56, 1
  v_or_b32 v3, s56, v3
  v_lshlrev_b32 v3, 1, v3
  v_and_b32 v4, 7, v1
  v_xor_b32 v3, v3, v4
  v_lshlrev_b32 v3, 4, v3
  v_add_u32 v13, v13, v3
  v_and_b32 v2, 31, v1
  v_lshlrev_b32 v2, 4, v2
  v_lshrrev_b32 v3, 5, v1
  v_mul_u32_u24 v3, 7168, v3
  v_add_u32 v12, v2, v3
  s_lshl_b32 s69, s67, 9
  s_add_u32 s69, s69, 0xd00000
  s_barrier
  s_barrier
  s_lshl_b32 s13, s59, 7
  s_add_u32 s13, s13, 0xd80000
  v_and_b32 v142, 31, v1
  v_min_u32 v142, 7, v142
  v_lshlrev_b32 v142, 2, v142
  s_mov_b32 s58, 0
  s_mov_b32 s16, 0
Lpoll_100006:
  s_and_b32 s17, s58, 3
  s_cmp_eq_u32 s17, 3
  s_cselect_b32 s17, 0, 0x8000
  s_add_u32 s17, s17, s13
  buffer_load_dword v143, v142, s[24:27], s17 offen sc1
  s_add_u32 s58, s58, 1
  s_cmp_gt_u32 s58, 0x80000
  s_cbranch_scc1 Lpoll_out_100007
  s_waitcnt vmcnt(0)
  v_cmp_eq_u32 vcc, v143, v140
  s_nop 1
  s_or_b32 s16, s16, vcc_lo
  s_cmp_lg_u32 s16, -1
  s_cbranch_scc1 Lpoll_100006
Lpoll_out_100007:
  s_add_u32 m0, s63, 0
  s_add_u32 s56, s62, 0
  s_add_u32 s57, s62, 28672
  buffer_load_dwordx4 v11, s[24:27], s56 offen sc1 lds
  s_add_u32 m0, s63, 4096
  s_nop 0
  buffer_load_dwordx4 v11, s[24:27], s57 offen sc1 lds
  s_add_u32 m0, s63, 8192
  s_add_u32 s56, s62, 4096
  s_add_u32 s57, s62, 32768
  buffer_load_dwordx4 v11, s[24:27], s56 offen sc1 lds
  s_add_u32 m0, s63, 12288
  s_nop 0
  buffer_load_dwordx4 v11, s[24:27], s57 offen sc1 lds
  s_add_u32 m0, s63, 16384
  s_add_u32 s56, s62, 8192
  s_add_u32 s57, s62, 36864
  buffer_load_dwordx4 v11, s[24:27], s56 offen sc1 lds
  s_add_u32 m0, s63, 20480
  s_nop 0
  buffer_load_dwordx4 v11, s[24:27], s57 offen sc1 lds
  s_waitcnt vmcnt(4)
  s_barrier
  s_add_u32 m0, s63, 24576
  s_add_u32 s56, s62, 12288
  s_add_u32 s57, s62, 40960
  buffer_load_dwordx4 v11, s[24:27], s56 offen sc1 lds
  s_add_u32 m0, s63, 28672
  s_nop 0
  buffer_load_dwordx4 v11, s[24:27], s57 offen sc1 lds
  s_add_u32 m0, s63, 32768
  s_add_u32 s56, s62, 16384
  s_add_u32 s57, s62, 45056
  buffer_load_dwordx4 v11, s[24:27], s56 offen sc1 lds
  s_add_u32 m0, s63, 36864
  s_nop 0
  buffer_load_dwordx4 v11, s[24:27], s57 offen sc1 lds
  s_add_u32 m0, s63, 40960
  s_add_u32 s56, s62, 20480
  s_add_u32 s57, s62, 49152
  buffer_load_dwordx4 v11, s[24:27], s56 offen sc1 lds
  s_add_u32 m0, s63, 45056
  s_nop 0
  buffer_load_dwordx4 v11, s[24:27], s57 offen sc1 lds
  s_add_u32 m0, s63, 49152
  s_add_u32 s56, s62, 24576
  s_add_u32 s57, s62, 53248
  buffer_load_dwordx4 v11, s[24:27], s56 offen sc1 lds
  s_add_u32 m0, s63, 53248
  s_nop 0
  buffer_load_dwordx4 v11, s[24:27], s57 offen sc1 lds
  s_waitcnt vmcnt(10)
  s_barrier
  s_lshl_b32 s57, s55, 10
  s_add_u32 m0, s57, 57344
  s_add_u32 s56, s68, 0
  buffer_load_dwordx4 v13, s[40:43], s56 offen lds
  s_lshl_b32 s57, s55, 10
  s_add_u32 m0, s57, 61440
  s_add_u32 s56, s68, 57344
  buffer_load_dwordx4 v13, s[40:43], s56 offen lds
  s_waitcnt vmcnt(10)
  s_barrier
  s_lshl_b32 s57, s55, 10
  s_add_u32 m0, s57, 65536
  s_add_u32 s56, s68, 114688
  buffer_load_dwordx4 v13, s[40:43], s56 offen lds
  s_lshl_b32 s57, s55, 10
  s_add_u32 m0, s57, 131072
  s_add_u32 s56, s68, 172032
  buffer_load_dwordx4 v13, s[40:43], s56 offen lds
  s_waitcnt vmcnt(10)
  s_barrier
  s_lshl_b32 s57, s55, 10
  s_add_u32 m0, s57, 135168
  s_add_u32 s56, s68, 229376
  buffer_load_dwordx4 v13, s[40:43], s56 offen lds
  s_lshl_b32 s57, s55, 10
  s_add_u32 m0, s57, 139264
  s_add_u32 s56, s68, 286720
  buffer_load_dwordx4 v13, s[40:43], s56 offen lds
  s_waitcnt vmcnt(10)
  s_barrier
  s_lshl_b32 s57, s55, 10
  s_add_u32 m0, s57, 143360
  s_add_u32 s56, s68, 344064
  buffer_load_dwordx4 v13, s[40:43], s56 offen lds
  s_lshl_b32 s57, s55, 10
  s_add_u32 m0, s57, 147456
  s_add_u32 s56, s68, 401408
  buffer_load_dwordx4 v13, s[40:43], s56 offen lds
  s_waitcnt vmcnt(10)
  s_barrier
  s_lshl_b32 s57, s55, 10
  s_add_u32 m0, s57, 151552
  s_add_u32 s56, s68, 458752
  buffer_load_dwordx4 v13, s[40:43], s56 offen lds
  s_lshl_b32 s57, s55, 10
  s_add_u32 m0, s57, 155648
  s_add_u32 s56, s68, 516096
  buffer_load_dwordx4 v13, s[40:43], s56 offen lds
  s_waitcnt vmcnt(10)
  s_barrier
  s_barrier
  s_lshl_b32 s57, s55, 10
  s_add_u32 m0, s57, 69632
  s_add_u32 s56, s68, 573440
  buffer_load_dwordx4 v13, s[40:43], s56 offen lds
  s_lshl_b32 s57, s55, 10
  s_add_u32 m0, s57, 73728
  s_add_u32 s56, s68, 630784
  buffer_load_dwordx4 v13, s[40:43], s56 offen lds
  s_lshl_b32 s57, s55, 10
  s_add_u32 m0, s57, 77824
  s_add_u32 s56, s68, 688128
  buffer_load_dwordx4 v13, s[40:43], s56 offen lds
  s_lshl_b32 s57, s55, 10
  s_add_u32 m0, s57, 81920
  s_add_u32 s56, s68, 745472
  buffer_load_dwordx4 v13, s[40:43], s56 offen lds
  s_lshl_b32 s57, s55, 10
  s_add_u32 m0, s57, 86016
  s_add_u32 s56, s68, 802816
  buffer_load_dwordx4 v13, s[40:43], s56 offen lds
  s_lshl_b32 s57, s55, 10
  s_add_u32 m0, s57, 90112
  s_add_u32 s56, s68, 860160
  buffer_load_dwordx4 v13, s[40:43], s56 offen lds
  s_lshl_b32 s57, s55, 10
  s_add_u32 m0, s57, 94208
  s_add_u32 s56, s68, 917504
  buffer_load_dwordx4 v13, s[40:43], s56 offen lds
  s_lshl_b32 s57, s55, 10
  s_add_u32 m0, s57, 0
  s_add_u32 s56, s68, 974848
  buffer_load_dwordx4 v13, s[40:43], s56 offen lds
  s_lshl_b32 s57, s55, 10
  s_add_u32 m0, s57, 4096
  s_add_u32 s56, s68, 1032192
  buffer_load_dwordx4 v13, s[40:43], s56 offen lds
  s_lshl_b32 s57, s55, 10
  s_add_u32 m0, s57, 8192
  s_add_u32 s56, s68, 1089536
  buffer_load_dwordx4 v13, s[40:43], s56 offen lds
  s_lshl_b32 s57, s55, 10
  s_add_u32 m0, s57, 12288
  s_add_u32 s56, s68, 1146880
  buffer_load_dwordx4 v13, s[40:43], s56 offen lds
  s_lshl_b32 s57, s55, 10
  s_add_u32 m0, s57, 16384
  s_add_u32 s56, s68, 1204224
  buffer_load_dwordx4 v13, s[40:43], s56 offen lds
  s_barrier
  s_lshl_b32 s57, s55, 10
  s_add_u32 m0, s57, 20480
  s_add_u32 s56, s68, 1261568
  buffer_load_dwordx4 v13, s[40:43], s56 offen lds
  s_lshl_b32 s57, s55, 10
  s_add_u32 m0, s57, 24576
  s_add_u32 s56, s68, 1318912
  buffer_load_dwordx4 v13, s[40:43], s56 offen lds
  s_lshl_b32 s57, s55, 10
  s_add_u32 m0, s57, 28672
  s_add_u32 s56, s68, 1376256
  buffer_load_dwordx4 v13, s[40:43], s56 offen lds
  s_lshl_b32 s57, s55, 10
  s_add_u32 m0, s57, 32768
  s_add_u32 s56, s68, 1433600
  buffer_load_dwordx4 v13, s[40:43], s56 offen lds
  s_lshl_b32 s57, s55, 10
  s_add_u32 m0, s57, 36864
  s_add_u32 s56, s68, 1490944
  buffer_load_dwordx4 v13, s[40:43], s56 offen lds
  s_lshl_b32 s57, s55, 10
  s_add_u32 m0, s57, 40960
  s_add_u32 s56, s68, 1548288
  buffer_load_dwordx4 v13, s[40:43], s56 offen lds
  s_waitcnt vmcnt(17)
  s_barrier
  s_waitcnt vmcnt(9)
  s_barrier
  s_lshl_b32 s13, s67, 2
  s_add_u32 s13, s13, 0xd82800
  s_mov_b32 s17, s13
  v_and_b32 v142, 31, v1
  v_min_u32 v142, 1, v142
  v_mul_u32_u24 v142, 14, v142
  v_lshlrev_b32 v142, 2, v142
  buffer_load_dword v143, v142, s[24:27], s17 offen sc1
  s_waitcnt vmcnt(2)
  s_barrier
  s_waitcnt vmcnt(0)
  v_cmp_eq_u32 vcc, v143, v140
  s_nop 1
  s_cmp_eq_u32 vcc_lo, -1
  s_cbranch_scc1 Lfc_100008
  v_and_b32 v142, 31, v1
  v_min_u32 v142, 1, v142
  v_mul_u32_u24 v142, 14, v142
  v_lshlrev_b32 v142, 2, v142
  s_mov_b32 s58, 0
  s_mov_b32 s16, 0
Lpoll_100009:
  s_and_b32 s17, s58, 3
  s_cmp_eq_u32 s17, 3
  s_cselect_b32 s17, 0, 0x8000
  s_add_u32 s17, s17, s13
  buffer_load_dword v143, v142, s[24:27], s17 offen sc1
  s_add_u32 s58, s58, 1
  s_cmp_gt_u32 s58, 0x80000
  s_cbranch_scc1 Lpoll_out_100010
  s_waitcnt vmcnt(0)
  v_cmp_eq_u32 vcc, v143, v140
  s_nop 1
  s_or_b32 s16, s16, vcc_lo
  s_cmp_lg_u32 s16, -1
  s_cbranch_scc1 Lpoll_100009
Lpoll_out_100010:
Lfc_100008:
  s_mov_b32 m0, 162816
  s_nop 0
  buffer_load_dwordx4 v12, s[24:27], s69 offen sc1 lds
  s_lshl_b32 s57, s55, 10
  s_add_u32 m0, s57, 45056
  s_add_u32 s56, s68, 128
  buffer_load_dwordx4 v13, s[40:43], s56 offen lds
  s_lshl_b32 s57, s55, 10
  s_add_u32 m0, s57, 49152
  s_add_u32 s56, s68, 57472
  buffer_load_dwordx4 v13, s[40:43], s56 offen lds
  s_lshl_b32 s57, s55, 10
  s_add_u32 m0, s57, 53248
  s_add_u32 s56, s68, 114816
  buffer_load_dwordx4 v13, s[40:43], s56 offen lds
  s_barrier
  s_lshl_b32 s57, s55, 10
  s_add_u32 m0, s57, 98304
  s_add_u32 s56, s68, 172160
  buffer_load_dwordx4 v13, s[40:43], s56 offen lds
  s_lshl_b32 s57, s55, 10
  s_add_u32 m0, s57, 102400
  s_add_u32 s56, s68, 229504
  buffer_load_dwordx4 v13, s[40:43], s56 offen lds
  s_lshl_b32 s57, s55, 10
  s_add_u32 m0, s57, 106496
  s_add_u32 s56, s68, 286848
  buffer_load_dwordx4 v13, s[40:43], s56 offen lds
  s_lshl_b32 s57, s55, 10
  s_add_u32 m0, s57, 110592
  s_add_u32 s56, s68, 344192
  buffer_load_dwordx4 v13, s[40:43], s56 offen lds
  s_lshl_b32 s57, s55, 10
  s_add_u32 m0, s57, 114688
  s_add_u32 s56, s68, 401536
  buffer_load_dwordx4 v13, s[40:43], s56 offen lds
  s_mul_i32 s56, s54, 9363
  s_lshr_b32 s56, s56, 16
  s_mul_i32 s57, s56, 7
  s_sub_u32 s60, s54, s57
  s_lshl_b32 s59, s53, 2
  s_add_u32 s59, s59, s56
  v_lshrrev_b32 v6, 3, v1
  v_and_b32 v7, 2, v6
  v_lshlrev_b32 v7, 1, v7
  v_and_b32 v8, 7, v1
  v_xor_b32 v7, v7, v8
  v_lshlrev_b32 v7, 4, v7
  v_mul_u32_u24 v6, 896, v6
  v_add_u32 v10, v6, v7
  v_lshlrev_b32 v11, 4, v1
  s_lshl_b32 s61, s60, 7
  s_mul_i32 s56, s55, 14336
  s_add_u32 s61, s61, s56
  s_lshl_b32 s63, s55, 10
  s_lshl_b32 s64, s55, 11
  s_lshl_b32 s56, s59, 1
  s_mul_i32 s56, s56, 114688
  s_add_u32 s62, s56, 0x400000
  s_add_u32 s62, s62, s63
  s_waitcnt vmcnt(8)
  s_barrier
  s_lshl_b32 s57, s55, 10
  s_add_u32 m0, s57, 118784
  s_add_u32 s56, s68, 458880
  buffer_load_dwordx4 v13, s[40:43], s56 offen lds
  s_lshl_b32 s57, s55, 10
  s_add_u32 m0, s57, 122880
  s_add_u32 s56, s68, 516224
  buffer_load_dwordx4 v13, s[40:43], s56 offen lds
  s_lshl_b32 s57, s55, 10
  s_add_u32 m0, s57, 126976
  s_add_u32 s56, s68, 573568
  buffer_load_dwordx4 v13, s[40:43], s56 offen lds
  s_lshr_b32 s56, s59, 1
  s_lshl_b32 s56, s56, 7
  s_add_u32 s13, s56, 0xd81800
  s_add_u32 s15, s56, 0xd82000
  s_lshl_b32 s57, s55, 10
  s_add_u32 m0, s57, 57344
  s_add_u32 s56, s68, 630912
  buffer_load_dwordx4 v13, s[40:43], s56 offen lds
  s_lshl_b32 s57, s55, 10
  s_add_u32 m0, s57, 61440
  s_add_u32 s56, s68, 688256
  buffer_load_dwordx4 v13, s[40:43], s56 offen lds
  s_lshl_b32 s57, s55, 10
  s_add_u32 m0, s57, 65536
  s_add_u32 s56, s68, 745600
  buffer_load_dwordx4 v13, s[40:43], s56 offen lds
  s_lshl_b32 s57, s55, 10
  s_add_u32 m0, s57, 131072
  s_add_u32 s56, s68, 802944
  buffer_load_dwordx4 v13, s[40:43], s56 offen lds
  s_barrier
  s_lshl_b32 s57, s55, 10
  s_add_u32 m0, s57, 135168
  s_add_u32 s56, s68, 860288
  buffer_load_dwordx4 v13, s[40:43], s56 offen lds
  s_lshl_b32 s57, s55, 10
  s_add_u32 m0, s57, 139264
  s_add_u32 s56, s68, 917632
  buffer_load_dwordx4 v13, s[40:43], s56 offen lds
  s_lshl_b32 s57, s55, 10
  s_add_u32 m0, s57, 143360
  s_add_u32 s56, s68, 974976
  buffer_load_dwordx4 v13, s[40:43], s56 offen lds
  s_lshl_b32 s57, s55, 10
  s_add_u32 m0, s57, 147456
  s_add_u32 s56, s68, 1032320
  buffer_load_dwordx4 v13, s[40:43], s56 offen lds
  s_lshl_b32 s57, s55, 10
  s_add_u32 m0, s57, 151552
  s_add_u32 s56, s68, 1089664
  buffer_load_dwordx4 v13, s[40:43], s56 offen lds
  s_lshl_b32 s57, s55, 10
  s_add_u32 m0, s57, 155648
  s_add_u32 s56, s68, 1147008
  buffer_load_dwordx4 v13, s[40:43], s56 offen lds
  s_lshl_b32 s57, s55, 10
  s_add_u32 m0, s57, 69632
  s_add_u32 s56, s68, 1204352
  buffer_load_dwordx4 v13, s[40:43], s56 offen lds
  s_lshl_b32 s57, s55, 10
  s_add_u32 m0, s57, 73728
  s_add_u32 s56, s68, 1261696
  buffer_load_dwordx4 v13, s[40:43], s56 offen lds
  s_waitcnt vmcnt(20)
  s_barrier
  s_lshl_b32 s57, s55, 10
  s_add_u32 m0, s57, 77824
  s_add_u32 s56, s68, 1319040
  buffer_load_dwordx4 v13, s[40:43], s56 offen lds
  s_lshl_b32 s57, s55, 10
  s_add_u32 m0, s57, 81920
  s_add_u32 s56, s68, 1376384
  buffer_load_dwordx4 v13, s[40:43], s56 offen lds
  s_lshl_b32 s57, s55, 10
  s_add_u32 m0, s57, 86016
  s_add_u32 s56, s68, 1433728
  buffer_load_dwordx4 v13, s[40:43], s56 offen lds
  s_lshl_b32 s57, s55, 10
  s_add_u32 m0, s57, 90112
  s_add_u32 s56, s68, 1491072
  buffer_load_dwordx4 v13, s[40:43], s56 offen lds
  s_lshl_b32 s57, s55, 10
  s_add_u32 m0, s57, 94208
  s_add_u32 s56, s68, 1548416
  buffer_load_dwordx4 v13, s[40:43], s56 offen lds
  s_add_u32 m0, s64, 0
  s_add_u32 s56, s61, 0
  s_add_u32 s57, s61, 6144
  buffer_load_dwordx4 v10, s[44:47], s56 offen lds
  buffer_load_dwordx4 v10, s[44:47], s57 offen offset:1024 lds
  s_waitcnt vmcnt(19)
  s_barrier
  s_add_u32 m0, s64, 8192
  s_add_u32 s56, s61, 114688
  s_add_u32 s57, s61, 120832
  buffer_load_dwordx4 v10, s[44:47], s56 offen lds
  buffer_load_dwordx4 v10, s[44:47], s57 offen offset:1024 lds
  s_waitcnt vmcnt(13)
  s_barrier
  s_add_u32 m0, s64, 16384
  s_add_u32 s56, s61, 229376
  s_add_u32 s57, s61, 235520
  buffer_load_dwordx4 v10, s[44:47], s56 offen lds
  buffer_load_dwordx4 v10, s[44:47], s57 offen offset:1024 lds
  s_waitcnt vmcnt(7)
  s_barrier
  s_add_u32 m0, s64, 24576
  s_add_u32 s56, s61, 344064
  s_add_u32 s57, s61, 350208
  buffer_load_dwordx4 v10, s[44:47], s56 offen lds
  buffer_load_dwordx4 v10, s[44:47], s57 offen offset:1024 lds
  s_waitcnt vmcnt(8)
  s_barrier
  s_add_u32 m0, s64, 32768
  s_add_u32 s56, s61, 458752
  s_add_u32 s57, s61, 464896
  buffer_load_dwordx4 v10, s[44:47], s56 offen lds
  buffer_load_dwordx4 v10, s[44:47], s57 offen offset:1024 lds
  s_barrier
  s_add_u32 m0, s64, 40960
  s_add_u32 s56, s61, 573440
  s_add_u32 s57, s61, 579584
  buffer_load_dwordx4 v10, s[44:47], s56 offen lds
  buffer_load_dwordx4 v10, s[44:47], s57 offen offset:1024 lds
  s_add_u32 m0, s64, 49152
  s_add_u32 s56, s61, 688128
  s_add_u32 s57, s61, 694272
  buffer_load_dwordx4 v10, s[44:47], s56 offen lds
  buffer_load_dwordx4 v10, s[44:47], s57 offen offset:1024 lds
  s_barrier
  s_add_u32 m0, s64, 98304
  s_add_u32 s56, s61, 802816
  s_add_u32 s57, s61, 808960
  buffer_load_dwordx4 v10, s[44:47], s56 offen lds
  buffer_load_dwordx4 v10, s[44:47], s57 offen offset:1024 lds
  s_add_u32 m0, s64, 106496
  s_add_u32 s56, s61, 917504
  s_add_u32 s57, s61, 923648
  buffer_load_dwordx4 v10, s[44:47], s56 offen lds
  buffer_load_dwordx4 v10, s[44:47], s57 offen offset:1024 lds
  s_add_u32 m0, s64, 114688
  s_add_u32 s56, s61, 1032192
  s_add_u32 s57, s61, 1038336
  buffer_load_dwordx4 v10, s[44:47], s56 offen lds
  buffer_load_dwordx4 v10, s[44:47], s57 offen offset:1024 lds
  s_add_u32 m0, s64, 122880
  s_add_u32 s56, s61, 1146880
  s_add_u32 s57, s61, 1153024
  buffer_load_dwordx4 v10, s[44:47], s56 offen lds
  buffer_load_dwordx4 v10, s[44:47], s57 offen offset:1024 lds
  s_barrier
  s_barrier
  v_and_b32 v142, 31, v1
  v_min_u32 v142, 13, v142
  v_lshlrev_b32 v142, 2, v142
  s_mov_b32 s58, 0
  s_mov_b32 s16, 0
Lpoll_100011:
  s_and_b32 s17, s58, 3
  s_cmp_eq_u32 s17, 3
  s_cselect_b32 s17, 0, 0x8000
  s_add_u32 s17, s17, s13
  buffer_load_dword v143, v142, s[24:27], s17 offen sc1
  s_add_u32 s58, s58, 1
  s_cmp_gt_u32 s58, 0x80000
  s_cbranch_scc1 Lpoll_out_100012
  s_waitcnt vmcnt(0)
  v_cmp_eq_u32 vcc, v143, v140
  s_nop 1
  s_or_b32 s16, s16, vcc_lo
  s_cmp_lg_u32 s16, -1
  s_cbranch_scc1 Lpoll_100011
Lpoll_out_100012:
  s_add_u32 m0, s63, 65536
  s_add_u32 s56, s62, 0
  s_add_u32 s57, s62, 114688
  buffer_load_dwordx4 v11, s[24:27], s56 offen sc1 lds
  s_add_u32 m0, s63, 69632
  s_nop 0
  buffer_load_dwordx4 v11, s[24:27], s57 offen sc1 lds
  s_add_u32 m0, s63, 73728
  s_add_u32 s56, s62, 8192
  s_add_u32 s57, s62, 122880
  buffer_load_dwordx4 v11, s[24:27], s56 offen sc1 lds
  s_add_u32 m0, s63, 77824
  s_nop 0
  buffer_load_dwordx4 v11, s[24:27], s57 offen sc1 lds
  s_add_u32 m0, s63, 81920
  s_add_u32 s56, s62, 16384
  s_add_u32 s57, s62, 131072
  buffer_load_dwordx4 v11, s[24:27], s56 offen sc1 lds
  s_add_u32 m0, s63, 86016
  s_nop 0
  buffer_load_dwordx4 v11, s[24:27], s57 offen sc1 lds
  s_add_u32 m0, s63, 90112
  s_add_u32 s56, s62, 24576
  s_add_u32 s57, s62, 139264
  buffer_load_dwordx4 v11, s[24:27], s56 offen sc1 lds
  s_add_u32 m0, s63, 94208
  s_nop 0
  buffer_load_dwordx4 v11, s[24:27], s57 offen sc1 lds
  s_barrier
  s_waitcnt vmcnt(6)
  s_barrier
  s_add_u32 m0, s63, 57344
  s_add_u32 s56, s62, 32768
  s_add_u32 s57, s62, 147456
  buffer_load_dwordx4 v11, s[24:27], s56 offen sc1 lds
  s_add_u32 m0, s63, 61440
  s_nop 0
  buffer_load_dwordx4 v11, s[24:27], s57 offen sc1 lds
  s_add_u32 m0, s63, 131072
  s_add_u32 s56, s62, 40960
  s_add_u32 s57, s62, 155648
  buffer_load_dwordx4 v11, s[24:27], s56 offen sc1 lds
  s_add_u32 m0, s63, 135168
  s_nop 0
  buffer_load_dwordx4 v11, s[24:27], s57 offen sc1 lds
  s_waitcnt vmcnt(8)
  s_barrier
  s_add_u32 m0, s63, 139264
  s_add_u32 s56, s62, 49152
  s_add_u32 s57, s62, 163840
  buffer_load_dwordx4 v11, s[24:27], s56 offen sc1 lds
  s_add_u32 m0, s63, 143360
  s_nop 0
  buffer_load_dwordx4 v11, s[24:27], s57 offen sc1 lds
  s_add_u32 m0, s63, 147456
  s_add_u32 s56, s62, 57344
  s_add_u32 s57, s62, 172032
  buffer_load_dwordx4 v11, s[24:27], s56 offen sc1 lds
  s_add_u32 m0, s63, 151552
  s_nop 0
  buffer_load_dwordx4 v11, s[24:27], s57 offen sc1 lds
  s_waitcnt vmcnt(10)
  s_barrier
  s_add_u32 m0, s63, 155648
  s_add_u32 s56, s62, 65536
  s_add_u32 s57, s62, 180224
  buffer_load_dwordx4 v11, s[24:27], s56 offen sc1 lds
  s_add_u32 m0, s63, 159744
  s_nop 0
  buffer_load_dwordx4 v11, s[24:27], s57 offen sc1 lds
  s_add_u32 m0, s63, 0
  s_add_u32 s56, s62, 73728
  s_add_u32 s57, s62, 188416
  buffer_load_dwordx4 v11, s[24:27], s56 offen sc1 lds
  s_add_u32 m0, s63, 4096
  s_nop 0
  buffer_load_dwordx4 v11, s[24:27], s57 offen sc1 lds
  s_waitcnt vmcnt(12)
  s_barrier
  s_add_u32 m0, s63, 65536
  s_add_u32 s56, s62, 81920
  s_add_u32 s57, s62, 196608
  buffer_load_dwordx4 v11, s[24:27], s56 offen sc1 lds
  s_add_u32 m0, s63, 69632
  s_nop 0
  buffer_load_dwordx4 v11, s[24:27], s57 offen sc1 lds
  s_add_u32 m0, s63, 8192
  s_add_u32 s56, s62, 90112
  s_add_u32 s57, s62, 204800
  buffer_load_dwordx4 v11, s[24:27], s56 offen sc1 lds
  s_add_u32 m0, s63, 12288
  s_nop 0
  buffer_load_dwordx4 v11, s[24:27], s57 offen sc1 lds
  s_waitcnt vmcnt(14)
  s_barrier
  s_add_u32 m0, s64, 73728
  s_add_u32 s56, s61, 1261568
  s_add_u32 s57, s61, 1267712
  buffer_load_dwordx4 v10, s[44:47], s56 offen lds
  buffer_load_dwordx4 v10, s[44:47], s57 offen offset:1024 lds
  s_add_u32 m0, s63, 16384
  s_add_u32 s56, s62, 98304
  s_add_u32 s57, s62, 212992
  buffer_load_dwordx4 v11, s[24:27], s56 offen sc1 lds
  s_add_u32 m0, s63, 20480
  s_nop 0
  buffer_load_dwordx4 v11, s[24:27], s57 offen sc1 lds
  s_waitcnt vmcnt(16)
  s_barrier
  s_add_u32 m0, s64, 81920
  s_add_u32 s56, s61, 1376256
  s_add_u32 s57, s61, 1382400
  buffer_load_dwordx4 v10, s[44:47], s56 offen lds
  buffer_load_dwordx4 v10, s[44:47], s57 offen offset:1024 lds
  s_add_u32 m0, s63, 24576
  s_add_u32 s56, s62, 106496
  s_add_u32 s57, s62, 221184
  buffer_load_dwordx4 v11, s[24:27], s56 offen sc1 lds
  s_add_u32 m0, s63, 28672
  s_nop 0
  buffer_load_dwordx4 v11, s[24:27], s57 offen sc1 lds
  s_waitcnt vmcnt(18)
  s_barrier
  s_add_u32 m0, s64, 90112
  s_add_u32 s56, s61, 1490944
  s_add_u32 s57, s61, 1497088
  buffer_load_dwordx4 v10, s[44:47], s56 offen lds
  buffer_load_dwordx4 v10, s[44:47], s57 offen offset:1024 lds
  v_and_b32 v142, 31, v1
  v_min_u32 v142, 13, v142
  v_lshlrev_b32 v142, 2, v142
  s_add_u32 s17, s15, 0x8000
  buffer_load_dword v143, v142, s[24:27], s17 offen sc1
  s_add_u32 m0, s64, 32768
  s_add_u32 s56, s61, 57344
  s_add_u32 s57, s61, 63488
  buffer_load_dwordx4 v10, s[44:47], s56 offen lds
  buffer_load_dwordx4 v10, s[44:47], s57 offen offset:1024 lds
  s_waitcnt vmcnt(21)
  s_barrier
  s_add_u32 m0, s64, 57344
  s_add_u32 s56, s61, 172032
  s_add_u32 s57, s61, 178176
  buffer_load_dwordx4 v10, s[44:47], s56 offen lds
  buffer_load_dwordx4 v10, s[44:47], s57 offen offset:1024 lds
  s_add_u32 m0, s64, 40960
  s_add_u32 s56, s61, 286720
  s_add_u32 s57, s61, 292864
  buffer_load_dwordx4 v10, s[44:47], s56 offen lds
  buffer_load_dwordx4 v10, s[44:47], s57 offen offset:1024 lds
  s_waitcnt vmcnt(23)
  s_barrier
  s_waitcnt vmcnt(6)
  v_cmp_eq_u32 vcc, v143, v140
  s_nop 1
  s_cmp_eq_u32 vcc_lo, -1
  s_cbranch_scc1 Lf3b_100013
  v_and_b32 v142, 31, v1
  v_min_u32 v142, 13, v142
  v_lshlrev_b32 v142, 2, v142
  s_mov_b32 s58, 0
  s_mov_b32 s16, 0
Lpoll_100014:
  s_and_b32 s17, s58, 3
  s_cmp_eq_u32 s17, 3
  s_cselect_b32 s17, 0, 0x8000
  s_add_u32 s17, s17, s15
  buffer_load_dword v143, v142, s[24:27], s17 offen sc1
  s_add_u32 s58, s58, 1
  s_cmp_gt_u32 s58, 0x80000
  s_cbranch_scc1 Lpoll_out_100015
  s_waitcnt vmcnt(0)
  v_cmp_eq_u32 vcc, v143, v140
  s_nop 1
  s_or_b32 s16, s16, vcc_lo
  s_cmp_lg_u32 s16, -1
  s_cbranch_scc1 Lpoll_100014
Lpoll_out_100015:
Lf3b_100013:
  s_add_u32 m0, s63, 131072
  s_add_u32 s56, s62, 4096
  s_add_u32 s57, s62, 118784
  buffer_load_dwordx4 v11, s[24:27], s56 offen sc1 lds
  s_add_u32 m0, s63, 135168
  s_nop 0
  buffer_load_dwordx4 v11, s[24:27], s57 offen sc1 lds
  s_add_u32 m0, s63, 49152
  s_add_u32 s56, s62, 12288
  s_add_u32 s57, s62, 126976
  buffer_load_dwordx4 v11, s[24:27], s56 offen sc1 lds
  s_add_u32 m0, s63, 53248
  s_nop 0
  buffer_load_dwordx4 v11, s[24:27], s57 offen sc1 lds
  s_barrier
  s_add_u32 m0, s63, 139264
  s_add_u32 s56, s62, 20480
  s_add_u32 s57, s62, 135168
  buffer_load_dwordx4 v11, s[24:27], s56 offen sc1 lds
  s_add_u32 m0, s63, 143360
  s_nop 0
  buffer_load_dwordx4 v11, s[24:27], s57 offen sc1 lds
  s_add_u32 m0, s63, 98304
  s_add_u32 s56, s62, 28672
  s_add_u32 s57, s62, 143360
  buffer_load_dwordx4 v11, s[24:27], s56 offen sc1 lds
  s_add_u32 m0, s63, 102400
  s_nop 0
  buffer_load_dwordx4 v11, s[24:27], s57 offen sc1 lds
  s_barrier
  s_add_u32 m0, s64, 147456
  s_add_u32 s56, s61, 401408
  s_add_u32 s57, s61, 407552
  buffer_load_dwordx4 v10, s[44:47], s56 offen lds
  buffer_load_dwordx4 v10, s[44:47], s57 offen offset:1024 lds
  s_add_u32 m0, s63, 106496
  s_add_u32 s56, s62, 36864
  s_add_u32 s57, s62, 151552
  buffer_load_dwordx4 v11, s[24:27], s56 offen sc1 lds
  s_add_u32 m0, s63, 110592
  s_nop 0
  buffer_load_dwordx4 v11, s[24:27], s57 offen sc1 lds
  s_barrier
  s_add_u32 m0, s64, 155648
  s_add_u32 s56, s61, 516096
  s_add_u32 s57, s61, 522240
  buffer_load_dwordx4 v10, s[44:47], s56 offen lds
  buffer_load_dwordx4 v10, s[44:47], s57 offen offset:1024 lds
  s_add_u32 m0, s63, 114688
  s_add_u32 s56, s62, 45056
  s_add_u32 s57, s62, 159744
  buffer_load_dwordx4 v11, s[24:27], s56 offen sc1 lds
  s_add_u32 m0, s63, 118784
  s_nop 0
  buffer_load_dwordx4 v11, s[24:27], s57 offen sc1 lds
  s_barrier
  s_add_u32 m0, s64, 0
  s_add_u32 s56, s61, 630784
  s_add_u32 s57, s61, 636928
  buffer_load_dwordx4 v10, s[44:47], s56 offen lds
  buffer_load_dwordx4 v10, s[44:47], s57 offen offset:1024 lds
  s_add_u32 m0, s63, 122880
  s_add_u32 s56, s62, 53248
  s_add_u32 s57, s62, 167936
  buffer_load_dwordx4 v11, s[24:27], s56 offen sc1 lds
  s_add_u32 m0, s63, 126976
  s_nop 0
  buffer_load_dwordx4 v11, s[24:27], s57 offen sc1 lds
  s_barrier
  s_add_u32 m0, s64, 65536
  s_add_u32 s56, s61, 745472
  s_add_u32 s57, s61, 751616
  buffer_load_dwordx4 v10, s[44:47], s56 offen lds
  buffer_load_dwordx4 v10, s[44:47], s57 offen offset:1024 lds
  s_add_u32 m0, s63, 73728
  s_add_u32 s56, s62, 61440
  s_add_u32 s57, s62, 176128
  buffer_load_dwordx4 v11, s[24:27], s56 offen sc1 lds
  s_add_u32 m0, s63, 77824
  s_nop 0
  buffer_load_dwordx4 v11, s[24:27], s57 offen sc1 lds
  s_waitcnt vmcnt(22)
  s_barrier
  s_add_u32 m0, s64, 8192
  s_add_u32 s56, s61, 860160
  s_add_u32 s57, s61, 866304
  buffer_load_dwordx4 v10, s[44:47], s56 offen lds
  buffer_load_dwordx4 v10, s[44:47], s57 offen offset:1024 lds
  s_add_u32 m0, s63, 81920
  s_add_u32 s56, s62, 69632
  s_add_u32 s57, s62, 184320
  buffer_load_dwordx4 v11, s[24:27], s56 offen sc1 lds
  s_add_u32 m0, s63, 86016
  s_nop 0
  buffer_load_dwordx4 v11, s[24:27], s57 offen sc1 lds
  s_waitcnt vmcnt(24)
  s_barrier
  s_add_u32 m0, s64, 16384
  s_add_u32 s56, s61, 974848
  s_add_u32 s57, s61, 980992
  buffer_load_dwordx4 v10, s[44:47], s56 offen lds
  buffer_load_dwordx4 v10, s[44:47], s57 offen offset:1024 lds
  s_add_u32 m0, s63, 90112
  s_add_u32 s56, s62, 77824
  s_add_u32 s57, s62, 192512
  buffer_load_dwordx4 v11, s[24:27], s56 offen sc1 lds
  s_add_u32 m0, s63, 94208
  s_nop 0
  buffer_load_dwordx4 v11, s[24:27], s57 offen sc1 lds
  s_waitcnt vmcnt(26)
  s_barrier
  s_add_u32 m0, s64, 24576
  s_add_u32 s56, s61, 1089536
  s_add_u32 s57, s61, 1095680
  buffer_load_dwordx4 v10, s[44:47], s56 offen lds
  buffer_load_dwordx4 v10, s[44:47], s57 offen offset:1024 lds
  s_add_u32 m0, s63, 32768
  s_add_u32 s56, s62, 86016
  s_add_u32 s57, s62, 200704
  buffer_load_dwordx4 v11, s[24:27], s56 offen sc1 lds
  s_add_u32 m0, s63, 36864
  s_nop 0
  buffer_load_dwordx4 v11, s[24:27], s57 offen sc1 lds
  s_waitcnt vmcnt(26)
  s_barrier
  s_add_u32 m0, s64, 131072
  s_add_u32 s56, s61, 1204224
  s_add_u32 s57, s61, 1210368
  buffer_load_dwordx4 v10, s[44:47], s56 offen lds
  buffer_load_dwordx4 v10, s[44:47], s57 offen offset:1024 lds
  s_add_u32 m0, s63, 57344
  s_add_u32 s56, s62, 94208
  s_add_u32 s57, s62, 208896
  buffer_load_dwordx4 v11, s[24:27], s56 offen sc1 lds
  s_add_u32 m0, s63, 61440
  s_nop 0
  buffer_load_dwordx4 v11, s[24:27], s57 offen sc1 lds
  s_waitcnt vmcnt(26)
  s_barrier
  s_add_u32 m0, s64, 49152
  s_add_u32 s56, s61, 1318912
  s_add_u32 s57, s61, 1325056
  buffer_load_dwordx4 v10, s[44:47], s56 offen lds
  buffer_load_dwordx4 v10, s[44:47], s57 offen offset:1024 lds
  s_add_u32 m0, s63, 40960
  s_add_u32 s56, s62, 102400
  s_add_u32 s57, s62, 217088
  buffer_load_dwordx4 v11, s[24:27], s56 offen sc1 lds
  s_add_u32 m0, s63, 45056
  s_nop 0
  buffer_load_dwordx4 v11, s[24:27], s57 offen sc1 lds
  s_waitcnt vmcnt(26)
  s_barrier
  s_add_u32 m0, s64, 139264
  s_add_u32 s56, s61, 1433600
  s_add_u32 s57, s61, 1439744
  buffer_load_dwordx4 v10, s[44:47], s56 offen lds
  buffer_load_dwordx4 v10, s[44:47], s57 offen offset:1024 lds
  s_add_u32 m0, s63, 147456
  s_add_u32 s56, s62, 110592
  s_add_u32 s57, s62, 225280
  buffer_load_dwordx4 v11, s[24:27], s56 offen sc1 lds
  s_add_u32 m0, s63, 151552
  s_nop 0
  buffer_load_dwordx4 v11, s[24:27], s57 offen sc1 lds
  s_waitcnt vmcnt(26)
  s_barrier
  s_add_u32 m0, s64, 98304
  s_add_u32 s56, s61, 1548288
  s_add_u32 s57, s61, 1554432
  buffer_load_dwordx4 v10, s[44:47], s56 offen lds
  buffer_load_dwordx4 v10, s[44:47], s57 offen offset:1024 lds
  s_waitcnt vmcnt(24)
  s_barrier
  s_waitcnt vmcnt(20)
  s_barrier
  s_waitcnt vmcnt(16)
  s_barrier
  s_waitcnt vmcnt(12)
  s_barrier
  s_waitcnt vmcnt(8)
  s_barrier
  s_waitcnt vmcnt(4)
  s_barrier
  s_waitcnt vmcnt(0)
  s_barrier
  s_branch Lend
Ll_job:
  s_barrier
  s_cmp_lg_u32 s55, 0
  s_cbranch_scc1 Lmw_100016
  v_min_u32 v6, 48, v1
  s_mul_i32 s56, s2, 49
  v_add_u32 v6, s56, v6
  v_lshlrev_b32 v6, 7, v6
  buffer_load_dword v139, v6, s[44:47], 0 offen
Lmw_100016:
  s_sub_u32 s56, s55, 1
  s_cmp_gt_u32 s56, 1
  s_cbranch_scc1 Lmw_100017
  v_min_u32 v6, 48, v1
  s_mul_i32 s56, s2, 49
  v_add_u32 v6, s56, v6
  v_lshlrev_b32 v6, 7, v6
  buffer_load_dword v139, v6, s[40:43], 0 offen
Lmw_100017:
  s_barrier
  s_barrier
  s_barrier
  s_branch Lend
Lend:
  s_endpgm
Lcode_end:
.section .rodata,"a"
.p2align 6
.amdhsa_kernel sequential_preLN__sliding_local_dilated__glu_gated_swiglu__prompt_kernel
  .amdhsa_next_free_vgpr 256
  .amdhsa_next_free_sgpr 102
  .amdhsa_accum_offset 144
  .amdhsa_group_segment_fixed_size 0
  .amdhsa_kernarg_size 80
  .amdhsa_user_sgpr_count 2
  .amdhsa_user_sgpr_kernarg_segment_ptr 1
  .amdhsa_system_sgpr_workgroup_id_x 1
.end_amdhsa_kernel
```
